```python
import torch

def _softmax(x, axis=-1):
    return torch.softmax(x, dim=axis)
def _gelu(x):
    return torch.nn.functional.gelu(x, approximate="tanh")
def _silu(x):
    return torch.nn.functional.silu(x)
def _sigmoid(x):
    return torch.sigmoid(x)
def _layernorm(x, axis=-1, eps=1e-5):
    m = x.mean(dim=axis, keepdim=True)
    v = x.var(dim=axis, keepdim=True, unbiased=False)
    return (x - m) / torch.sqrt(v + eps)
def _scatter_add(tgt, idx, src, axis=0):
    return tgt.clone().index_add_(axis, idx, src)
def _segment_sum(src, seg, n):
    out = torch.zeros((n,) + src.shape[1:], dtype=src.dtype)
    return out.index_add_(0, seg, src)
def _pad(x, pw):
    flat = tuple(v for pair in reversed(pw) for v in pair)
    return torch.nn.functional.pad(x, flat)

kernel_name = 'sequential_preLN__sliding_local_dilated__dense_activation_relu__prompt'

def setup_inputs():

    _w = (lambda a: (lambda t: t.to(torch.bfloat16) if t.is_floating_point() else t)(torch.as_tensor(a)))
    def _A_setup():
        B, S, D = 1, 2048, 512
        return {
            "x": _w((lambda *s: torch.randn(*s, dtype=torch.bfloat16) * 0.05)(B, S, D)),
            "wqkv": _w((lambda *s: torch.randn(*s, dtype=torch.bfloat16) * 0.05)(D, 3 * D)),
            "wo": _w((lambda *s: torch.randn(*s, dtype=torch.bfloat16) * 0.05)(D, D)),
        }
    _A_in = _A_setup()

    def _B_setup():
        B, S, D, Dff = 1, 2048, 512, 1376
        return {
            "x": _w((lambda *s: torch.randn(*s, dtype=torch.bfloat16) * 0.05)(B, S, D)),
            "w1": _w((lambda *s: torch.randn(*s, dtype=torch.bfloat16) * 0.05)(D, Dff)),
            "w2": _w((lambda *s: torch.randn(*s, dtype=torch.bfloat16) * 0.05)(Dff, D)),
        }
    _B_in = _B_setup()

    return {
        "A_x": _A_in["x"],
        "A_wqkv": _A_in["wqkv"],
        "A_wo": _A_in["wo"],
        "B_x": _B_in["x"],
        "B_w1": _B_in["w1"],
        "B_w2": _B_in["w2"],
    }

def reference(A_x, A_wqkv, A_wo, B_x, B_w1, B_w2):
    def _A_ref(x, wqkv, wo):
        B, S, D = x.shape
        H = 32; Dh = D // H
        W, dil = 8, 2
        qkv = (lambda x, *d: x.permute(*d))((x @ wqkv).reshape(B, S, 3, H, Dh), 2, 0, 3, 1, 4)
        q, k, v = qkv[0], qkv[1], qkv[2]
        scale = Dh ** -0.5
        pos = torch.arange(S)
        off = torch.arange(W) * dil
        idx = pos[:, None] - off[None, :]
        mask = idx >= 0
        idx_c = torch.where(mask, idx, 0).reshape(-1)
        kg = k[:, :, idx_c, :].reshape(B, H, S, W, Dh)
        vg = v[:, :, idx_c, :].reshape(B, H, S, W, Dh)
        logits = torch.einsum("bhsd,bhswd->bhsw", q, kg) * scale
        logits = torch.where(mask[None, None, :, :], logits, -1e9)
        attn = _softmax(logits, axis=-1)
        o = torch.einsum("bhsw,bhswd->bhsd", attn, vg)
        return (lambda x, *d: x.permute(*d))(o, 0, 2, 1, 3).reshape(B, S, D) @ wo

    def _B_ref(x, w1, w2):
        h = torch.einsum("bsd,df->bsf", x, w1)
        zero = torch.zeros_like(h)
        h = torch.maximum(h, zero)
        return torch.einsum("bsf,fd->bsd", h, w2)

    x = A_x
    h = x + _A_ref(_layernorm(x, axis=-1), A_wqkv, A_wo)
    h2 = h + _B_ref(_layernorm(h, axis=-1), B_w1, B_w2)
    return h2
```

```asm
; @launch grid=(256,1,1) block=(256,1,1) lds=161408
.amdgcn_target "amdgcn-amd-amdhsa--gfx950"
.text
.globl sequential_preLN__sliding_local_dilated__dense_activation_relu__prompt_kernel
.p2align 8
.type sequential_preLN__sliding_local_dilated__dense_activation_relu__prompt_kernel,@function
sequential_preLN__sliding_local_dilated__dense_activation_relu__prompt_kernel:
    s_cmp_ge_u32 s2, 256
    s_cbranch_scc1 END
    s_load_dwordx16 s[4:19], s[0:1], 0
    s_load_dwordx2 s[20:21], s[0:1], 64
    v_and_b32 v38, 63, v0
    v_lshrrev_b32 v32, 6, v0
    v_and_b32 v2, 15, v0
    v_bfe_u32 v3, v0, 4, 2
    v_readfirstlane_b32 s64, v32
    v_lshlrev_b32 v1, 4, v38
    s_and_b32 s65, s2, 7
    s_lshr_b32 s3, s2, 6
    s_lshl_b32 s84, s3, 3
    s_add_u32 s65, s65, s84
    s_bfe_u32 s66, s2, 0x30003
    s_lshl_b32 s67, s65, 16
    s_getreg_b32 s84, hwreg(HW_REG_XCC_ID, 0, 4)
    s_add_u32 s84, s84, 1
    v_mov_b32 v28, s84
    s_add_u32 s68, s67, 0
    s_add_u32 s69, s67, 16384
    s_add_u32 s70, s67, 32768
    s_add_u32 s71, s67, 49152
    s_lshl_b32 s84, s64, 2
    v_add_u32 v32, s84, v3
    v_lshlrev_b32 v33, 10, v32
    v_lshl_add_u32 v4, v2, 4, v33
    s_lshl_b32 s83, s3, 8
    s_cmp_eq_u32 s3, 3
    s_movk_i32 s87, 0x100
    s_cselect_b32 s87, -768, s87
    s_cmp_eq_u32 s3, 2
    s_movk_i32 s88, 0x100
    s_cselect_b32 s88, -768, s88
    s_cmp_eq_u32 s3, 1
    s_movk_i32 s90, 0x100
    s_cselect_b32 s90, -768, s90
    v_add_u32 v4, s83, v4
    s_lshr_b32 s84, s2, 3
    s_lshl_b32 s84, s84, 2
    s_add_u32 s84, s84, s64
    s_mul_i32 s84, s84, 12288
    s_add_u32 s84, s84, 384
    v_and_b32 v32, 3, v38
    v_mul_u32_u24 v32, 3072, v32
    v_bfe_u32 v33, v38, 2, 2
    v_min_u32 v33, 2, v33
    v_lshl_add_u32 v158, v33, 10, v32
    v_add_u32 v158, s84, v158
    s_sub_u32 s85, s67, 16384
    v_add_u32 v156, s85, v4
    s_mul_i32 s80, s64, 19456
    s_add_u32 s80, s80, 81920
    s_mul_i32 s84, s64, 3
    s_lshl_b32 s85, s66, 7
    s_mul_i32 s91, s66, 384
    s_mul_i32 s81, s64, 96
    s_add_u32 s91, s91, s81
    v_add_u32 v32, 0, v38
    v_mul_u32_u24 v33, 171, v32
    v_lshrrev_b32 v33, 10, v33
    v_mul_u32_u24 v34, 6, v33
    v_sub_u32 v34, v32, v34
    v_bfe_u32 v35, v33, 2, 2
    v_and_b32 v36, 3, v33
    v_lshl_add_u32 v35, v35, 3, v36
    v_lshrrev_b32 v36, 4, v33
    v_lshl_add_u32 v35, v36, 2, v35
    v_lshrrev_b32 v36, 1, v34
    v_add_u32 v36, s84, v36
    v_lshrrev_b32 v37, 2, v36
    v_lshlrev_b32 v37, 10, v37
    v_and_b32 v36, 3, v36
    v_lshl_add_u32 v37, v36, 5, v37
    v_and_b32 v36, 1, v34
    v_lshl_add_u32 v37, v36, 4, v37
    v_add_u32 v37, s85, v37
    v_mul_u32_u24 v36, 3072, v35
    v_add_u32 v37, v37, v36
    v_subrev_u32 v14, 0, v37
    v_mul_u32_u24 v36, 2752, v35
    v_lshl_add_u32 v36, v34, 4, v36
    v_add_u32 v36, s91, v36
    v_subrev_u32 v17, 0, v36
    v_add_u32 v32, 64, v38
    v_mul_u32_u24 v33, 171, v32
    v_lshrrev_b32 v33, 10, v33
    v_mul_u32_u24 v34, 6, v33
    v_sub_u32 v34, v32, v34
    v_bfe_u32 v35, v33, 2, 2
    v_and_b32 v36, 3, v33
    v_lshl_add_u32 v35, v35, 3, v36
    v_lshrrev_b32 v36, 4, v33
    v_lshl_add_u32 v35, v36, 2, v35
    v_lshrrev_b32 v36, 1, v34
    v_add_u32 v36, s84, v36
    v_lshrrev_b32 v37, 2, v36
    v_lshlrev_b32 v37, 10, v37
    v_and_b32 v36, 3, v36
    v_lshl_add_u32 v37, v36, 5, v37
    v_and_b32 v36, 1, v34
    v_lshl_add_u32 v37, v36, 4, v37
    v_add_u32 v37, s85, v37
    v_mul_u32_u24 v36, 3072, v35
    v_add_u32 v37, v37, v36
    v_subrev_u32 v15, 1024, v37
    v_mul_u32_u24 v36, 2752, v35
    v_lshl_add_u32 v36, v34, 4, v36
    v_add_u32 v36, s91, v36
    v_subrev_u32 v18, 1024, v36
    v_add_u32 v32, 128, v38
    v_mul_u32_u24 v33, 171, v32
    v_lshrrev_b32 v33, 10, v33
    v_mul_u32_u24 v34, 6, v33
    v_sub_u32 v34, v32, v34
    v_bfe_u32 v35, v33, 2, 2
    v_and_b32 v36, 3, v33
    v_lshl_add_u32 v35, v35, 3, v36
    v_lshrrev_b32 v36, 4, v33
    v_lshl_add_u32 v35, v36, 2, v35
    v_lshrrev_b32 v36, 1, v34
    v_add_u32 v36, s84, v36
    v_lshrrev_b32 v37, 2, v36
    v_lshlrev_b32 v37, 10, v37
    v_and_b32 v36, 3, v36
    v_lshl_add_u32 v37, v36, 5, v37
    v_and_b32 v36, 1, v34
    v_lshl_add_u32 v37, v36, 4, v37
    v_add_u32 v37, s85, v37
    v_mul_u32_u24 v36, 3072, v35
    v_add_u32 v37, v37, v36
    v_subrev_u32 v16, 2048, v37
    v_mul_u32_u24 v36, 2752, v35
    v_lshl_add_u32 v36, v34, 4, v36
    v_add_u32 v36, s91, v36
    v_subrev_u32 v19, 2048, v36
    s_waitcnt lgkmcnt(0)
    s_mov_b32 s24, s4
    s_and_b32 s25, s5, 0xffff
    s_mov_b32 s26, 2097152
    s_mov_b32 s27, 0x00020000
    s_add_u32 s60, s20, 4194304
    s_addc_u32 s61, s21, 0
    s_and_b32 s61, s61, 0xffff
    s_mov_b32 s62, 6455296
    s_mov_b32 s63, 0x00020000
    s_mov_b32 s48, s18
    s_and_b32 s49, s19, 0xffff
    s_mov_b32 s50, 256
    s_mov_b32 s51, 0x00020000
    v_mov_b32 v36, 0
    v_mov_b32 v37, 0
    v_mul_u32_u24 v35, 128, v0
    s_mov_b32 s84, 6291456
    s_cmp_lg_u32 s2, 0
    s_cbranch_scc1 NOINIT
    buffer_store_dwordx2 v[36:37], v35, s[60:63], s84 offen sc1
NOINIT:
    s_mov_b32 s28, s6
    s_and_b32 s29, s7, 0xffff
    s_mov_b32 s30, 1572864
    s_mov_b32 s31, 0x00020000
    buffer_load_dwordx4 v[160:163], v156, s[24:27], 0 offen
    buffer_load_dwordx4 v[176:179], v4, s[24:27], s68 offen
    buffer_load_dwordx4 v[192:195], v4, s[24:27], s69 offen
    buffer_load_dwordx4 v[208:211], v4, s[24:27], s70 offen
    buffer_load_dwordx4 v[224:227], v4, s[24:27], s71 offen
    v_add_u32 v4, s87, v4
    v_add_u32 v156, s87, v156
    buffer_load_dwordx4 v[164:167], v156, s[24:27], 0 offen
    buffer_load_dwordx4 v[180:183], v4, s[24:27], s68 offen
    buffer_load_dwordx4 v[196:199], v4, s[24:27], s69 offen
    buffer_load_dwordx4 v[212:215], v4, s[24:27], s70 offen
    buffer_load_dwordx4 v[228:231], v4, s[24:27], s71 offen
    s_mov_b64 exec, 0xfff
    buffer_load_dword v159, v158, s[28:31], 0 offen
    s_mov_b64 exec, -1
    s_mov_b32 s32, s8
    s_and_b32 s33, s9, 0xffff
    s_mov_b32 s34, 524288
    s_mov_b32 s35, 0x00020000
    s_mov_b32 s36, s12
    s_and_b32 s37, s13, 0xffff
    s_mov_b32 s38, 1409024
    s_mov_b32 s39, 0x00020000
    s_mov_b32 s40, s14
    s_and_b32 s41, s15, 0xffff
    s_mov_b32 s42, 1409024
    s_mov_b32 s43, 0x00020000
    s_mov_b32 s44, s16
    s_and_b32 s45, s17, 0xffff
    s_mov_b32 s46, 2097152
    s_mov_b32 s47, 0x00020000
    s_mov_b32 s52, s20
    s_and_b32 s53, s21, 0xffff
    s_mov_b32 s54, 2097152
    s_mov_b32 s55, 0x00020000
    s_add_u32 s56, s20, 2097152
    s_addc_u32 s57, s21, 0
    s_and_b32 s57, s57, 0xffff
    s_mov_b32 s58, 2097152
    s_mov_b32 s59, 0x00020000
    s_add_u32 s84, s64, 0
    s_and_b32 s84, s84, 3
    s_lshl_b32 s84, s84, 14
    s_add_u32 s72, s67, s84
    s_mul_i32 s76, s72, 3
    s_add_u32 s84, s64, 1
    s_and_b32 s84, s84, 3
    s_lshl_b32 s84, s84, 14
    s_add_u32 s73, s67, s84
    s_mul_i32 s77, s73, 3
    s_add_u32 s84, s64, 2
    s_and_b32 s84, s84, 3
    s_lshl_b32 s84, s84, 14
    s_add_u32 s74, s67, s84
    s_mul_i32 s78, s74, 3
    s_add_u32 s84, s64, 3
    s_and_b32 s84, s84, 3
    s_lshl_b32 s84, s84, 14
    s_add_u32 s75, s67, s84
    s_mul_i32 s79, s75, 3
    s_mul_i32 s82, s65, 1024
    s_add_u32 s82, s82, 6291456
    s_mul_i32 s84, s66, 128
    s_add_u32 s92, s82, s84
    s_mov_b32 s86, 0x3f803f80
    s_lshl_b32 s89, s64, 17
    s_mov_b32 s93, 98304
    s_lshl_b32 s84, s64, 2
    v_add_u32 v32, s84, v3
    v_xor_b32 v33, v2, v32
    v_lshlrev_b32 v33, 4, v33
    v_lshl_add_u32 v5, v32, 10, v33
    v_add_u32 v5, s83, v5
    v_add_u32 v157, 0x10000, v5
    v_lshlrev_b32 v30, 3, v32
    v_add_u32 v30, 159744, v30
    v_lshlrev_b32 v29, 3, v2
    v_add_u32 v29, 159744, v29
    v_xor_b32 v33, v2, v3
    v_xor_b32 v34, 0, v33
    v_lshlrev_b32 v34, 4, v34
    v_lshl_add_u32 v6, v2, 10, v34
    v_add_u32 v6, s83, v6
    v_add_u32 v10, 0x10000, v6
    v_xor_b32 v34, 4, v33
    v_lshlrev_b32 v34, 4, v34
    v_lshl_add_u32 v7, v2, 10, v34
    v_add_u32 v7, s83, v7
    v_add_u32 v11, 0x10000, v7
    v_xor_b32 v34, 8, v33
    v_lshlrev_b32 v34, 4, v34
    v_lshl_add_u32 v8, v2, 10, v34
    v_add_u32 v8, s83, v8
    v_add_u32 v12, 0x10000, v8
    v_xor_b32 v34, 12, v33
    v_lshlrev_b32 v34, 4, v34
    v_lshl_add_u32 v9, v2, 10, v34
    v_add_u32 v9, s83, v9
    v_add_u32 v13, 0x10000, v9
    v_lshrrev_b32 v32, 2, v38
    v_and_b32 v33, 3, v38
    v_mul_u32_u24 v34, 96, v32
    v_add_u32 v34, s80, v34
    v_lshl_add_u32 v24, v33, 3, v34
    v_mul_u32_u24 v35, 24, v33
    v_add_u32 v25, v35, v34
    v_bfe_u32 v35, v38, 3, 1
    v_lshl_add_u32 v35, v35, 2, v33
    v_lshlrev_b32 v35, 4, v35
    v_lshl_add_u32 v35, v32, 7, v35
    v_xor_b32 v36, 64, v35
    v_add_u32 v26, s80, v35
    v_add_u32 v27, s80, v36
    v_lshrrev_b32 v32, 5, v38
    v_bfe_u32 v33, v38, 3, 2
    v_lshl_add_u32 v32, v32, 3, v33
    v_and_b32 v33, 7, v38
    v_bfe_u32 v34, v38, 4, 1
    v_lshlrev_b32 v34, 2, v34
    v_xor_b32 v33, v33, v34
    v_lshlrev_b32 v33, 4, v33
    v_lshl_add_u32 v32, v32, 10, v33
    s_lshl_b32 s85, s66, 7
    v_add_u32 v32, s85, v32
    v_add_u32 v20, 0, v32
    v_add_u32 v21, 15360, v32
    v_add_u32 v22, 2048, v32
    v_add_u32 v23, 17408, v32
    s_lshl_b32 s84, s64, 8
    v_lshlrev_b32 v32, 4, v3
    v_lshl_add_u32 v32, v2, 10, v32
    s_add_u32 s84, s85, s72
    v_add_u32 v31, s84, v32
    v_mov_b32 v246, 0
    v_mov_b32 v247, 0
    v_mov_b32 v248, 0
    v_mov_b32 v249, 0
    v_mov_b32 v250, 0
    v_mov_b32 v251, 0
    v_mov_b32 v252, 0
    v_mov_b32 v253, 0
    v_mov_b32 v254, 0
    v_mov_b32 v255, 0
    v_add_u32 v4, s88, v4
    v_add_u32 v156, s88, v156
    buffer_load_dwordx4 v[168:171], v156, s[24:27], 0 offen
    buffer_load_dwordx4 v[184:187], v4, s[24:27], s68 offen
    buffer_load_dwordx4 v[200:203], v4, s[24:27], s69 offen
    buffer_load_dwordx4 v[216:219], v4, s[24:27], s70 offen
    buffer_load_dwordx4 v[232:235], v4, s[24:27], s71 offen
    v_add_u32 v4, s90, v4
    v_add_u32 v156, s90, v156
    buffer_load_dwordx4 v[172:175], v156, s[24:27], 0 offen
    buffer_load_dwordx4 v[188:191], v4, s[24:27], s68 offen
    buffer_load_dwordx4 v[204:207], v4, s[24:27], s69 offen
    buffer_load_dwordx4 v[220:223], v4, s[24:27], s70 offen
    buffer_load_dwordx4 v[236:239], v4, s[24:27], s71 offen
    s_cmp_eq_u32 s64, 0
    s_cselect_b32 s84, 0xffff, 0
    s_waitcnt vmcnt(20)
    s_mov_b32 exec_lo, s84
    s_mov_b32 exec_hi, 0
    v_mov_b32 v160, s86
    v_mov_b32 v161, s86
    v_mov_b32 v162, s86
    v_mov_b32 v163, s86
    s_mov_b64 exec, -1
    ds_write_b128 v5, v[160:163] offset:0
    v_dot2c_f32_bf16 v246, s86, v160
    v_dot2c_f32_bf16 v247, v160, v160
    v_dot2c_f32_bf16 v246, s86, v161
    v_dot2c_f32_bf16 v247, v161, v161
    v_dot2c_f32_bf16 v246, s86, v162
    v_dot2c_f32_bf16 v247, v162, v162
    v_dot2c_f32_bf16 v246, s86, v163
    v_dot2c_f32_bf16 v247, v163, v163
    s_waitcnt vmcnt(19)
    ds_write_b128 v5, v[176:179] offset:16384
    v_dot2c_f32_bf16 v248, s86, v176
    v_dot2c_f32_bf16 v249, v176, v176
    v_dot2c_f32_bf16 v248, s86, v177
    v_dot2c_f32_bf16 v249, v177, v177
    v_dot2c_f32_bf16 v248, s86, v178
    v_dot2c_f32_bf16 v249, v178, v178
    v_dot2c_f32_bf16 v248, s86, v179
    v_dot2c_f32_bf16 v249, v179, v179
    s_waitcnt vmcnt(18)
    ds_write_b128 v5, v[192:195] offset:32768
    v_dot2c_f32_bf16 v250, s86, v192
    v_dot2c_f32_bf16 v251, v192, v192
    v_dot2c_f32_bf16 v250, s86, v193
    v_dot2c_f32_bf16 v251, v193, v193
    v_dot2c_f32_bf16 v250, s86, v194
    v_dot2c_f32_bf16 v251, v194, v194
    v_dot2c_f32_bf16 v250, s86, v195
    v_dot2c_f32_bf16 v251, v195, v195
    s_waitcnt vmcnt(17)
    ds_write_b128 v5, v[208:211] offset:49152
    v_dot2c_f32_bf16 v252, s86, v208
    v_dot2c_f32_bf16 v253, v208, v208
    v_dot2c_f32_bf16 v252, s86, v209
    v_dot2c_f32_bf16 v253, v209, v209
    v_dot2c_f32_bf16 v252, s86, v210
    v_dot2c_f32_bf16 v253, v210, v210
    v_dot2c_f32_bf16 v252, s86, v211
    v_dot2c_f32_bf16 v253, v211, v211
    s_waitcnt vmcnt(16)
    ds_write_b128 v157, v[224:227]
    v_dot2c_f32_bf16 v254, s86, v224
    v_dot2c_f32_bf16 v255, v224, v224
    v_dot2c_f32_bf16 v254, s86, v225
    v_dot2c_f32_bf16 v255, v225, v225
    v_dot2c_f32_bf16 v254, s86, v226
    v_dot2c_f32_bf16 v255, v226, v226
    v_dot2c_f32_bf16 v254, s86, v227
    v_dot2c_f32_bf16 v255, v227, v227
    s_add_u32 m0, s80, 0
    s_add_u32 s81, s3, 0
    s_and_b32 s81, s81, 3
    s_mul_i32 s81, s81, 393216
    buffer_load_dwordx4 v14, s[28:31], s81 offen offset:0 lds
    buffer_load_dwordx4 v15, s[28:31], s81 offen offset:1024 lds
    buffer_load_dwordx4 v16, s[28:31], s81 offen offset:2048 lds
    v_add_u32 v5, s87, v5
    v_add_u32 v157, s87, v157
    s_cmp_eq_u32 s64, 0
    s_cselect_b32 s84, 0xffff, 0
    s_waitcnt vmcnt(18)
    s_mov_b32 exec_lo, s84
    s_mov_b32 exec_hi, 0
    v_mov_b32 v164, s86
    v_mov_b32 v165, s86
    v_mov_b32 v166, s86
    v_mov_b32 v167, s86
    s_mov_b64 exec, -1
    ds_write_b128 v5, v[164:167] offset:0
    v_dot2c_f32_bf16 v246, s86, v164
    v_dot2c_f32_bf16 v247, v164, v164
    v_dot2c_f32_bf16 v246, s86, v165
    v_dot2c_f32_bf16 v247, v165, v165
    v_dot2c_f32_bf16 v246, s86, v166
    v_dot2c_f32_bf16 v247, v166, v166
    v_dot2c_f32_bf16 v246, s86, v167
    v_dot2c_f32_bf16 v247, v167, v167
    s_waitcnt vmcnt(17)
    ds_write_b128 v5, v[180:183] offset:16384
    v_dot2c_f32_bf16 v248, s86, v180
    v_dot2c_f32_bf16 v249, v180, v180
    v_dot2c_f32_bf16 v248, s86, v181
    v_dot2c_f32_bf16 v249, v181, v181
    v_dot2c_f32_bf16 v248, s86, v182
    v_dot2c_f32_bf16 v249, v182, v182
    v_dot2c_f32_bf16 v248, s86, v183
    v_dot2c_f32_bf16 v249, v183, v183
    s_waitcnt vmcnt(16)
    ds_write_b128 v5, v[196:199] offset:32768
    v_dot2c_f32_bf16 v250, s86, v196
    v_dot2c_f32_bf16 v251, v196, v196
    v_dot2c_f32_bf16 v250, s86, v197
    v_dot2c_f32_bf16 v251, v197, v197
    v_dot2c_f32_bf16 v250, s86, v198
    v_dot2c_f32_bf16 v251, v198, v198
    v_dot2c_f32_bf16 v250, s86, v199
    v_dot2c_f32_bf16 v251, v199, v199
    s_waitcnt vmcnt(15)
    ds_write_b128 v5, v[212:215] offset:49152
    v_dot2c_f32_bf16 v252, s86, v212
    v_dot2c_f32_bf16 v253, v212, v212
    v_dot2c_f32_bf16 v252, s86, v213
    v_dot2c_f32_bf16 v253, v213, v213
    v_dot2c_f32_bf16 v252, s86, v214
    v_dot2c_f32_bf16 v253, v214, v214
    v_dot2c_f32_bf16 v252, s86, v215
    v_dot2c_f32_bf16 v253, v215, v215
    s_waitcnt vmcnt(14)
    ds_write_b128 v157, v[228:231]
    v_dot2c_f32_bf16 v254, s86, v228
    v_dot2c_f32_bf16 v255, v228, v228
    v_dot2c_f32_bf16 v254, s86, v229
    v_dot2c_f32_bf16 v255, v229, v229
    v_dot2c_f32_bf16 v254, s86, v230
    v_dot2c_f32_bf16 v255, v230, v230
    v_dot2c_f32_bf16 v254, s86, v231
    v_dot2c_f32_bf16 v255, v231, v231
    s_add_u32 m0, s80, 3072
    s_add_u32 s81, s3, 0
    s_and_b32 s81, s81, 3
    s_mul_i32 s81, s81, 393216
    s_add_u32 s81, s81, 98304
    buffer_load_dwordx4 v14, s[28:31], s81 offen offset:0 lds
    buffer_load_dwordx4 v15, s[28:31], s81 offen offset:1024 lds
    buffer_load_dwordx4 v16, s[28:31], s81 offen offset:2048 lds
    v_add_u32 v5, s88, v5
    v_add_u32 v157, s88, v157
    s_cmp_eq_u32 s64, 0
    s_cselect_b32 s84, 0xffff, 0
    s_waitcnt vmcnt(15)
    s_mov_b32 exec_lo, s84
    s_mov_b32 exec_hi, 0
    v_mov_b32 v168, s86
    v_mov_b32 v169, s86
    v_mov_b32 v170, s86
    v_mov_b32 v171, s86
    s_mov_b64 exec, -1
    ds_write_b128 v5, v[168:171] offset:0
    v_dot2c_f32_bf16 v246, s86, v168
    v_dot2c_f32_bf16 v247, v168, v168
    v_dot2c_f32_bf16 v246, s86, v169
    v_dot2c_f32_bf16 v247, v169, v169
    v_dot2c_f32_bf16 v246, s86, v170
    v_dot2c_f32_bf16 v247, v170, v170
    v_dot2c_f32_bf16 v246, s86, v171
    v_dot2c_f32_bf16 v247, v171, v171
    s_waitcnt vmcnt(14)
    ds_write_b128 v5, v[184:187] offset:16384
    v_dot2c_f32_bf16 v248, s86, v184
    v_dot2c_f32_bf16 v249, v184, v184
    v_dot2c_f32_bf16 v248, s86, v185
    v_dot2c_f32_bf16 v249, v185, v185
    v_dot2c_f32_bf16 v248, s86, v186
    v_dot2c_f32_bf16 v249, v186, v186
    v_dot2c_f32_bf16 v248, s86, v187
    v_dot2c_f32_bf16 v249, v187, v187
    s_waitcnt vmcnt(13)
    ds_write_b128 v5, v[200:203] offset:32768
    v_dot2c_f32_bf16 v250, s86, v200
    v_dot2c_f32_bf16 v251, v200, v200
    v_dot2c_f32_bf16 v250, s86, v201
    v_dot2c_f32_bf16 v251, v201, v201
    v_dot2c_f32_bf16 v250, s86, v202
    v_dot2c_f32_bf16 v251, v202, v202
    v_dot2c_f32_bf16 v250, s86, v203
    v_dot2c_f32_bf16 v251, v203, v203
    s_waitcnt vmcnt(12)
    ds_write_b128 v5, v[216:219] offset:49152
    v_dot2c_f32_bf16 v252, s86, v216
    v_dot2c_f32_bf16 v253, v216, v216
    v_dot2c_f32_bf16 v252, s86, v217
    v_dot2c_f32_bf16 v253, v217, v217
    v_dot2c_f32_bf16 v252, s86, v218
    v_dot2c_f32_bf16 v253, v218, v218
    v_dot2c_f32_bf16 v252, s86, v219
    v_dot2c_f32_bf16 v253, v219, v219
    s_waitcnt vmcnt(11)
    ds_write_b128 v157, v[232:235]
    v_dot2c_f32_bf16 v254, s86, v232
    v_dot2c_f32_bf16 v255, v232, v232
    v_dot2c_f32_bf16 v254, s86, v233
    v_dot2c_f32_bf16 v255, v233, v233
    v_dot2c_f32_bf16 v254, s86, v234
    v_dot2c_f32_bf16 v255, v234, v234
    v_dot2c_f32_bf16 v254, s86, v235
    v_dot2c_f32_bf16 v255, v235, v235
    v_add_u32 v5, s90, v5
    v_add_u32 v157, s90, v157
    s_cmp_eq_u32 s64, 0
    s_cselect_b32 s84, 0xffff, 0
    s_waitcnt vmcnt(10)
    s_mov_b32 exec_lo, s84
    s_mov_b32 exec_hi, 0
    v_mov_b32 v172, s86
    v_mov_b32 v173, s86
    v_mov_b32 v174, s86
    v_mov_b32 v175, s86
    s_mov_b64 exec, -1
    ds_write_b128 v5, v[172:175] offset:0
    v_dot2c_f32_bf16 v246, s86, v172
    v_dot2c_f32_bf16 v247, v172, v172
    v_dot2c_f32_bf16 v246, s86, v173
    v_dot2c_f32_bf16 v247, v173, v173
    v_dot2c_f32_bf16 v246, s86, v174
    v_dot2c_f32_bf16 v247, v174, v174
    v_dot2c_f32_bf16 v246, s86, v175
    v_dot2c_f32_bf16 v247, v175, v175
    s_waitcnt vmcnt(9)
    ds_write_b128 v5, v[188:191] offset:16384
    v_dot2c_f32_bf16 v248, s86, v188
    v_dot2c_f32_bf16 v249, v188, v188
    v_dot2c_f32_bf16 v248, s86, v189
    v_dot2c_f32_bf16 v249, v189, v189
    v_dot2c_f32_bf16 v248, s86, v190
    v_dot2c_f32_bf16 v249, v190, v190
    v_dot2c_f32_bf16 v248, s86, v191
    v_dot2c_f32_bf16 v249, v191, v191
    s_waitcnt vmcnt(8)
    ds_write_b128 v5, v[204:207] offset:32768
    v_dot2c_f32_bf16 v250, s86, v204
    v_dot2c_f32_bf16 v251, v204, v204
    v_dot2c_f32_bf16 v250, s86, v205
    v_dot2c_f32_bf16 v251, v205, v205
    v_dot2c_f32_bf16 v250, s86, v206
    v_dot2c_f32_bf16 v251, v206, v206
    v_dot2c_f32_bf16 v250, s86, v207
    v_dot2c_f32_bf16 v251, v207, v207
    s_waitcnt vmcnt(7)
    ds_write_b128 v5, v[220:223] offset:49152
    v_dot2c_f32_bf16 v252, s86, v220
    v_dot2c_f32_bf16 v253, v220, v220
    v_dot2c_f32_bf16 v252, s86, v221
    v_dot2c_f32_bf16 v253, v221, v221
    v_dot2c_f32_bf16 v252, s86, v222
    v_dot2c_f32_bf16 v253, v222, v222
    v_dot2c_f32_bf16 v252, s86, v223
    v_dot2c_f32_bf16 v253, v223, v223
    s_waitcnt vmcnt(6)
    ds_write_b128 v157, v[236:239]
    v_dot2c_f32_bf16 v254, s86, v236
    v_dot2c_f32_bf16 v255, v236, v236
    v_dot2c_f32_bf16 v254, s86, v237
    v_dot2c_f32_bf16 v255, v237, v237
    v_dot2c_f32_bf16 v254, s86, v238
    v_dot2c_f32_bf16 v255, v238, v238
    v_dot2c_f32_bf16 v254, s86, v239
    v_dot2c_f32_bf16 v255, v239, v239
    s_waitcnt lgkmcnt(0)
    s_barrier
    s_cmp_lg_u32 s2, 0
    s_cbranch_scc1 NOANN
    s_cmp_lg_u32 s64, 0
    s_cbranch_scc1 NOANN
    v_mov_b32 v34, 1
    s_mov_b64 exec, 1
    buffer_store_dword v34, off, s[48:51], 0 sc1
    s_mov_b64 exec, -1
NOANN:
    ds_read_b128 v[116:119], v6 offset:0
    ds_read_b128 v[120:123], v6 offset:16384
    ds_read_b128 v[124:127], v6 offset:32768
    ds_read_b128 v[128:131], v6 offset:49152
    ds_read_b128 v[132:135], v10
    s_waitcnt vmcnt(3)
    ds_read_b64_tr_b16 v[92:93], v24 offset:0
    ds_read_b64_tr_b16 v[94:95], v24 offset:1536
    ds_read_b64_tr_b16 v[96:97], v24 offset:32
    ds_read_b64_tr_b16 v[98:99], v24 offset:1568
    ds_read_b64_tr_b16 v[100:101], v24 offset:64
    ds_read_b64_tr_b16 v[102:103], v24 offset:1600
    s_waitcnt lgkmcnt(0)
    v_mfma_f32_16x16x32_bf16 v[32:35], v[92:95], v[116:119], 0
    v_mfma_f32_16x16x32_bf16 v[36:39], v[96:99], v[116:119], 0
    ds_read_b128 v[136:139], v7 offset:0
    ds_read_b128 v[140:143], v7 offset:16384
    v_mfma_f32_16x16x32_bf16 v[40:43], v[100:103], v[116:119], 0
    ds_read_b128 v[144:147], v7 offset:32768
    ds_read_b128 v[148:151], v7 offset:49152
    v_mfma_f32_16x16x32_bf16 v[44:47], v[92:95], v[120:123], 0
    ds_read_b128 v[152:155], v11
    s_waitcnt vmcnt(0)
    v_mfma_f32_16x16x32_bf16 v[48:51], v[96:99], v[120:123], 0
    ds_read_b64_tr_b16 v[104:105], v24 offset:3072
    ds_read_b64_tr_b16 v[106:107], v24 offset:4608
    v_mfma_f32_16x16x32_bf16 v[52:55], v[100:103], v[120:123], 0
    ds_read_b64_tr_b16 v[108:109], v24 offset:3104
    ds_read_b64_tr_b16 v[110:111], v24 offset:4640
    v_mfma_f32_16x16x32_bf16 v[56:59], v[92:95], v[124:127], 0
    ds_read_b64_tr_b16 v[112:113], v24 offset:3136
    ds_read_b64_tr_b16 v[114:115], v24 offset:4672
    v_mfma_f32_16x16x32_bf16 v[60:63], v[96:99], v[124:127], 0
    s_add_u32 m0, s80, 6144
    s_add_u32 s81, s3, 1
    s_and_b32 s81, s81, 3
    s_mul_i32 s81, s81, 393216
    buffer_load_dwordx4 v14, s[28:31], s81 offen offset:0 lds
    v_mfma_f32_16x16x32_bf16 v[64:67], v[100:103], v[124:127], 0
    buffer_load_dwordx4 v15, s[28:31], s81 offen offset:1024 lds
    buffer_load_dwordx4 v16, s[28:31], s81 offen offset:2048 lds
    v_mfma_f32_16x16x32_bf16 v[68:71], v[92:95], v[128:131], 0
    s_add_u32 m0, s80, 9216
    s_add_u32 s81, s3, 1
    s_and_b32 s81, s81, 3
    s_mul_i32 s81, s81, 393216
    s_add_u32 s81, s81, 98304
    buffer_load_dwordx4 v14, s[28:31], s81 offen offset:0 lds
    v_mfma_f32_16x16x32_bf16 v[72:75], v[96:99], v[128:131], 0
    buffer_load_dwordx4 v15, s[28:31], s81 offen offset:1024 lds
    buffer_load_dwordx4 v16, s[28:31], s81 offen offset:2048 lds
    v_mfma_f32_16x16x32_bf16 v[76:79], v[100:103], v[128:131], 0
    v_mfma_f32_16x16x32_bf16 v[80:83], v[92:95], v[132:135], 0
    v_mfma_f32_16x16x32_bf16 v[84:87], v[96:99], v[132:135], 0
    v_mfma_f32_16x16x32_bf16 v[88:91], v[100:103], v[132:135], 0
    s_waitcnt lgkmcnt(0)
    v_mfma_f32_16x16x32_bf16 v[32:35], v[104:107], v[136:139], v[32:35]
    v_mfma_f32_16x16x32_bf16 v[36:39], v[108:111], v[136:139], v[36:39]
    v_add_u32 v6, s87, v6
    v_add_u32 v10, s87, v10
    v_mfma_f32_16x16x32_bf16 v[40:43], v[112:115], v[136:139], v[40:43]
    ds_read_b128 v[116:119], v6 offset:0
    ds_read_b128 v[120:123], v6 offset:16384
    v_mfma_f32_16x16x32_bf16 v[44:47], v[104:107], v[140:143], v[44:47]
    ds_read_b128 v[124:127], v6 offset:32768
    ds_read_b128 v[128:131], v6 offset:49152
    v_mfma_f32_16x16x32_bf16 v[48:51], v[108:111], v[140:143], v[48:51]
    ds_read_b128 v[132:135], v10
    s_waitcnt vmcnt(3)
    v_mfma_f32_16x16x32_bf16 v[52:55], v[112:115], v[140:143], v[52:55]
    ds_read_b64_tr_b16 v[92:93], v24 offset:6144
    ds_read_b64_tr_b16 v[94:95], v24 offset:7680
    v_mfma_f32_16x16x32_bf16 v[56:59], v[104:107], v[144:147], v[56:59]
    ds_read_b64_tr_b16 v[96:97], v24 offset:6176
    ds_read_b64_tr_b16 v[98:99], v24 offset:7712
    v_mfma_f32_16x16x32_bf16 v[60:63], v[108:111], v[144:147], v[60:63]
    ds_read_b64_tr_b16 v[100:101], v24 offset:6208
    ds_read_b64_tr_b16 v[102:103], v24 offset:7744
    v_mfma_f32_16x16x32_bf16 v[64:67], v[112:115], v[144:147], v[64:67]
    s_add_u32 m0, s80, 12288
    s_add_u32 s81, s3, 2
    s_and_b32 s81, s81, 3
    s_mul_i32 s81, s81, 393216
    buffer_load_dwordx4 v14, s[28:31], s81 offen offset:0 lds
    v_mfma_f32_16x16x32_bf16 v[68:71], v[104:107], v[148:151], v[68:71]
    buffer_load_dwordx4 v15, s[28:31], s81 offen offset:1024 lds
    buffer_load_dwordx4 v16, s[28:31], s81 offen offset:2048 lds
    v_mfma_f32_16x16x32_bf16 v[72:75], v[108:111], v[148:151], v[72:75]
    s_add_u32 m0, s80, 15360
    s_add_u32 s81, s3, 2
    s_and_b32 s81, s81, 3
    s_mul_i32 s81, s81, 393216
    s_add_u32 s81, s81, 98304
    buffer_load_dwordx4 v14, s[28:31], s81 offen offset:0 lds
    v_mfma_f32_16x16x32_bf16 v[76:79], v[112:115], v[148:151], v[76:79]
    buffer_load_dwordx4 v15, s[28:31], s81 offen offset:1024 lds
    buffer_load_dwordx4 v16, s[28:31], s81 offen offset:2048 lds
    v_mfma_f32_16x16x32_bf16 v[80:83], v[104:107], v[152:155], v[80:83]
    v_add_f32_dpp v246, v246, v246 row_ror:8 row_mask:0xf bank_mask:0xf
    v_add_f32_dpp v247, v247, v247 row_ror:8 row_mask:0xf bank_mask:0xf
    v_mfma_f32_16x16x32_bf16 v[84:87], v[108:111], v[152:155], v[84:87]
    v_add_f32_dpp v248, v248, v248 row_ror:8 row_mask:0xf bank_mask:0xf
    v_add_f32_dpp v249, v249, v249 row_ror:8 row_mask:0xf bank_mask:0xf
    v_mfma_f32_16x16x32_bf16 v[88:91], v[112:115], v[152:155], v[88:91]
    v_add_f32_dpp v250, v250, v250 row_ror:8 row_mask:0xf bank_mask:0xf
    v_add_f32_dpp v251, v251, v251 row_ror:8 row_mask:0xf bank_mask:0xf
    v_add_f32_dpp v252, v252, v252 row_ror:8 row_mask:0xf bank_mask:0xf
    v_add_f32_dpp v253, v253, v253 row_ror:8 row_mask:0xf bank_mask:0xf
    s_waitcnt lgkmcnt(0)
    v_mfma_f32_16x16x32_bf16 v[32:35], v[92:95], v[116:119], v[32:35]
    v_mfma_f32_16x16x32_bf16 v[36:39], v[96:99], v[116:119], v[36:39]
    v_add_u32 v7, s87, v7
    v_add_u32 v11, s87, v11
    v_mfma_f32_16x16x32_bf16 v[40:43], v[100:103], v[116:119], v[40:43]
    ds_read_b128 v[136:139], v7 offset:0
    ds_read_b128 v[140:143], v7 offset:16384
    v_mfma_f32_16x16x32_bf16 v[44:47], v[92:95], v[120:123], v[44:47]
    ds_read_b128 v[144:147], v7 offset:32768
    ds_read_b128 v[148:151], v7 offset:49152
    v_mfma_f32_16x16x32_bf16 v[48:51], v[96:99], v[120:123], v[48:51]
    ds_read_b128 v[152:155], v11
    s_waitcnt vmcnt(6)
    v_mfma_f32_16x16x32_bf16 v[52:55], v[100:103], v[120:123], v[52:55]
    ds_read_b64_tr_b16 v[104:105], v24 offset:9216
    ds_read_b64_tr_b16 v[106:107], v24 offset:10752
    v_mfma_f32_16x16x32_bf16 v[56:59], v[92:95], v[124:127], v[56:59]
    ds_read_b64_tr_b16 v[108:109], v24 offset:9248
    ds_read_b64_tr_b16 v[110:111], v24 offset:10784
    v_mfma_f32_16x16x32_bf16 v[60:63], v[96:99], v[124:127], v[60:63]
    ds_read_b64_tr_b16 v[112:113], v24 offset:9280
    ds_read_b64_tr_b16 v[114:115], v24 offset:10816
    v_mfma_f32_16x16x32_bf16 v[64:67], v[100:103], v[124:127], v[64:67]
    s_add_u32 m0, s80, 0
    s_add_u32 s81, s3, 3
    s_and_b32 s81, s81, 3
    s_mul_i32 s81, s81, 393216
    buffer_load_dwordx4 v14, s[28:31], s81 offen offset:0 lds
    v_mfma_f32_16x16x32_bf16 v[68:71], v[92:95], v[128:131], v[68:71]
    buffer_load_dwordx4 v15, s[28:31], s81 offen offset:1024 lds
    buffer_load_dwordx4 v16, s[28:31], s81 offen offset:2048 lds
    v_mfma_f32_16x16x32_bf16 v[72:75], v[96:99], v[128:131], v[72:75]
    s_add_u32 m0, s80, 3072
    s_add_u32 s81, s3, 3
    s_and_b32 s81, s81, 3
    s_mul_i32 s81, s81, 393216
    s_add_u32 s81, s81, 98304
    buffer_load_dwordx4 v14, s[28:31], s81 offen offset:0 lds
    v_mfma_f32_16x16x32_bf16 v[76:79], v[100:103], v[128:131], v[76:79]
    buffer_load_dwordx4 v15, s[28:31], s81 offen offset:1024 lds
    buffer_load_dwordx4 v16, s[28:31], s81 offen offset:2048 lds
    v_mfma_f32_16x16x32_bf16 v[80:83], v[92:95], v[132:135], v[80:83]
    v_add_f32_dpp v254, v254, v254 row_ror:8 row_mask:0xf bank_mask:0xf
    v_add_f32_dpp v255, v255, v255 row_ror:8 row_mask:0xf bank_mask:0xf
    v_mfma_f32_16x16x32_bf16 v[84:87], v[96:99], v[132:135], v[84:87]
    v_add_f32_dpp v246, v246, v246 row_ror:4 row_mask:0xf bank_mask:0xf
    v_add_f32_dpp v247, v247, v247 row_ror:4 row_mask:0xf bank_mask:0xf
    v_mfma_f32_16x16x32_bf16 v[88:91], v[100:103], v[132:135], v[88:91]
    v_add_f32_dpp v248, v248, v248 row_ror:4 row_mask:0xf bank_mask:0xf
    v_add_f32_dpp v249, v249, v249 row_ror:4 row_mask:0xf bank_mask:0xf
    v_add_f32_dpp v250, v250, v250 row_ror:4 row_mask:0xf bank_mask:0xf
    v_add_f32_dpp v251, v251, v251 row_ror:4 row_mask:0xf bank_mask:0xf
    s_waitcnt lgkmcnt(0)
    v_mfma_f32_16x16x32_bf16 v[32:35], v[104:107], v[136:139], v[32:35]
    v_mfma_f32_16x16x32_bf16 v[36:39], v[108:111], v[136:139], v[36:39]
    v_add_u32 v6, s88, v6
    v_add_u32 v10, s88, v10
    v_mfma_f32_16x16x32_bf16 v[40:43], v[112:115], v[136:139], v[40:43]
    ds_read_b128 v[116:119], v6 offset:0
    ds_read_b128 v[120:123], v6 offset:16384
    v_mfma_f32_16x16x32_bf16 v[44:47], v[104:107], v[140:143], v[44:47]
    ds_read_b128 v[124:127], v6 offset:32768
    ds_read_b128 v[128:131], v6 offset:49152
    v_mfma_f32_16x16x32_bf16 v[48:51], v[108:111], v[140:143], v[48:51]
    ds_read_b128 v[132:135], v10
    s_waitcnt vmcnt(9)
    v_mfma_f32_16x16x32_bf16 v[52:55], v[112:115], v[140:143], v[52:55]
    ds_read_b64_tr_b16 v[92:93], v24 offset:12288
    ds_read_b64_tr_b16 v[94:95], v24 offset:13824
    v_mfma_f32_16x16x32_bf16 v[56:59], v[104:107], v[144:147], v[56:59]
    ds_read_b64_tr_b16 v[96:97], v24 offset:12320
    ds_read_b64_tr_b16 v[98:99], v24 offset:13856
    v_mfma_f32_16x16x32_bf16 v[60:63], v[108:111], v[144:147], v[60:63]
    ds_read_b64_tr_b16 v[100:101], v24 offset:12352
    ds_read_b64_tr_b16 v[102:103], v24 offset:13888
    v_mfma_f32_16x16x32_bf16 v[64:67], v[112:115], v[144:147], v[64:67]
    s_add_u32 m0, s80, 6144
    s_add_u32 s81, s3, 0
    s_and_b32 s81, s81, 3
    s_mul_i32 s81, s81, 393216
    s_add_u32 s81, s81, 196608
    buffer_load_dwordx4 v14, s[28:31], s81 offen offset:0 lds
    v_mfma_f32_16x16x32_bf16 v[68:71], v[104:107], v[148:151], v[68:71]
    buffer_load_dwordx4 v15, s[28:31], s81 offen offset:1024 lds
    buffer_load_dwordx4 v16, s[28:31], s81 offen offset:2048 lds
    v_mfma_f32_16x16x32_bf16 v[72:75], v[108:111], v[148:151], v[72:75]
    s_add_u32 m0, s80, 9216
    s_add_u32 s81, s3, 0
    s_and_b32 s81, s81, 3
    s_mul_i32 s81, s81, 393216
    s_add_u32 s81, s81, 294912
    buffer_load_dwordx4 v14, s[28:31], s81 offen offset:0 lds
    v_mfma_f32_16x16x32_bf16 v[76:79], v[112:115], v[148:151], v[76:79]
    buffer_load_dwordx4 v15, s[28:31], s81 offen offset:1024 lds
    buffer_load_dwordx4 v16, s[28:31], s81 offen offset:2048 lds
    v_mfma_f32_16x16x32_bf16 v[80:83], v[104:107], v[152:155], v[80:83]
    v_add_f32_dpp v252, v252, v252 row_ror:4 row_mask:0xf bank_mask:0xf
    v_add_f32_dpp v253, v253, v253 row_ror:4 row_mask:0xf bank_mask:0xf
    v_mfma_f32_16x16x32_bf16 v[84:87], v[108:111], v[152:155], v[84:87]
    v_add_f32_dpp v254, v254, v254 row_ror:4 row_mask:0xf bank_mask:0xf
    v_add_f32_dpp v255, v255, v255 row_ror:4 row_mask:0xf bank_mask:0xf
    v_mfma_f32_16x16x32_bf16 v[88:91], v[112:115], v[152:155], v[88:91]
    v_add_f32_dpp v246, v246, v246 row_ror:2 row_mask:0xf bank_mask:0xf
    v_add_f32_dpp v247, v247, v247 row_ror:2 row_mask:0xf bank_mask:0xf
    v_add_f32_dpp v248, v248, v248 row_ror:2 row_mask:0xf bank_mask:0xf
    v_add_f32_dpp v249, v249, v249 row_ror:2 row_mask:0xf bank_mask:0xf
    s_waitcnt lgkmcnt(0)
    v_mfma_f32_16x16x32_bf16 v[32:35], v[92:95], v[116:119], v[32:35]
    v_mfma_f32_16x16x32_bf16 v[36:39], v[96:99], v[116:119], v[36:39]
    v_add_u32 v7, s88, v7
    v_add_u32 v11, s88, v11
    v_mfma_f32_16x16x32_bf16 v[40:43], v[100:103], v[116:119], v[40:43]
    ds_read_b128 v[136:139], v7 offset:0
    ds_read_b128 v[140:143], v7 offset:16384
    v_mfma_f32_16x16x32_bf16 v[44:47], v[92:95], v[120:123], v[44:47]
    ds_read_b128 v[144:147], v7 offset:32768
    ds_read_b128 v[148:151], v7 offset:49152
    v_mfma_f32_16x16x32_bf16 v[48:51], v[96:99], v[120:123], v[48:51]
    ds_read_b128 v[152:155], v11
    s_waitcnt vmcnt(12)
    v_mfma_f32_16x16x32_bf16 v[52:55], v[100:103], v[120:123], v[52:55]
    ds_read_b64_tr_b16 v[104:105], v24 offset:15360
    ds_read_b64_tr_b16 v[106:107], v24 offset:16896
    v_mfma_f32_16x16x32_bf16 v[56:59], v[92:95], v[124:127], v[56:59]
    ds_read_b64_tr_b16 v[108:109], v24 offset:15392
    ds_read_b64_tr_b16 v[110:111], v24 offset:16928
    v_mfma_f32_16x16x32_bf16 v[60:63], v[96:99], v[124:127], v[60:63]
    ds_read_b64_tr_b16 v[112:113], v24 offset:15424
    ds_read_b64_tr_b16 v[114:115], v24 offset:16960
    v_mfma_f32_16x16x32_bf16 v[64:67], v[100:103], v[124:127], v[64:67]
    s_add_u32 m0, s80, 12288
    s_add_u32 s81, s3, 1
    s_and_b32 s81, s81, 3
    s_mul_i32 s81, s81, 393216
    s_add_u32 s81, s81, 196608
    buffer_load_dwordx4 v14, s[28:31], s81 offen offset:0 lds
    v_mfma_f32_16x16x32_bf16 v[68:71], v[92:95], v[128:131], v[68:71]
    buffer_load_dwordx4 v15, s[28:31], s81 offen offset:1024 lds
    buffer_load_dwordx4 v16, s[28:31], s81 offen offset:2048 lds
    v_mfma_f32_16x16x32_bf16 v[72:75], v[96:99], v[128:131], v[72:75]
    v_add_f32_dpp v250, v250, v250 row_ror:2 row_mask:0xf bank_mask:0xf
    v_add_f32_dpp v251, v251, v251 row_ror:2 row_mask:0xf bank_mask:0xf
    v_mfma_f32_16x16x32_bf16 v[76:79], v[100:103], v[128:131], v[76:79]
    v_add_f32_dpp v252, v252, v252 row_ror:2 row_mask:0xf bank_mask:0xf
    v_add_f32_dpp v253, v253, v253 row_ror:2 row_mask:0xf bank_mask:0xf
    v_mfma_f32_16x16x32_bf16 v[80:83], v[92:95], v[132:135], v[80:83]
    v_add_f32_dpp v254, v254, v254 row_ror:2 row_mask:0xf bank_mask:0xf
    v_add_f32_dpp v255, v255, v255 row_ror:2 row_mask:0xf bank_mask:0xf
    v_mfma_f32_16x16x32_bf16 v[84:87], v[96:99], v[132:135], v[84:87]
    v_add_f32_dpp v246, v246, v246 row_ror:1 row_mask:0xf bank_mask:0xf
    v_add_f32_dpp v247, v247, v247 row_ror:1 row_mask:0xf bank_mask:0xf
    v_mfma_f32_16x16x32_bf16 v[88:91], v[100:103], v[132:135], v[88:91]
    s_waitcnt lgkmcnt(0)
    v_mfma_f32_16x16x32_bf16 v[32:35], v[104:107], v[136:139], v[32:35]
    v_mfma_f32_16x16x32_bf16 v[36:39], v[108:111], v[136:139], v[36:39]
    v_add_u32 v6, s90, v6
    v_add_u32 v10, s90, v10
    v_mfma_f32_16x16x32_bf16 v[40:43], v[112:115], v[136:139], v[40:43]
    ds_read_b128 v[116:119], v6 offset:0
    ds_read_b128 v[120:123], v6 offset:16384
    v_mfma_f32_16x16x32_bf16 v[44:47], v[104:107], v[140:143], v[44:47]
    ds_read_b128 v[124:127], v6 offset:32768
    ds_read_b128 v[128:131], v6 offset:49152
    v_mfma_f32_16x16x32_bf16 v[48:51], v[108:111], v[140:143], v[48:51]
    ds_read_b128 v[132:135], v10
    s_waitcnt vmcnt(12)
    v_mfma_f32_16x16x32_bf16 v[52:55], v[112:115], v[140:143], v[52:55]
    ds_read_b64_tr_b16 v[92:93], v24 offset:0
    ds_read_b64_tr_b16 v[94:95], v24 offset:1536
    v_mfma_f32_16x16x32_bf16 v[56:59], v[104:107], v[144:147], v[56:59]
    ds_read_b64_tr_b16 v[96:97], v24 offset:32
    ds_read_b64_tr_b16 v[98:99], v24 offset:1568
    v_mfma_f32_16x16x32_bf16 v[60:63], v[108:111], v[144:147], v[60:63]
    ds_read_b64_tr_b16 v[100:101], v24 offset:64
    ds_read_b64_tr_b16 v[102:103], v24 offset:1600
    v_mfma_f32_16x16x32_bf16 v[64:67], v[112:115], v[144:147], v[64:67]
    s_add_u32 m0, s80, 15360
    s_add_u32 s81, s3, 1
    s_and_b32 s81, s81, 3
    s_mul_i32 s81, s81, 393216
    s_add_u32 s81, s81, 294912
    buffer_load_dwordx4 v14, s[28:31], s81 offen offset:0 lds
    v_mfma_f32_16x16x32_bf16 v[68:71], v[104:107], v[148:151], v[68:71]
    buffer_load_dwordx4 v15, s[28:31], s81 offen offset:1024 lds
    buffer_load_dwordx4 v16, s[28:31], s81 offen offset:2048 lds
    v_mfma_f32_16x16x32_bf16 v[72:75], v[108:111], v[148:151], v[72:75]
    v_add_f32_dpp v248, v248, v248 row_ror:1 row_mask:0xf bank_mask:0xf
    v_add_f32_dpp v249, v249, v249 row_ror:1 row_mask:0xf bank_mask:0xf
    v_mfma_f32_16x16x32_bf16 v[76:79], v[112:115], v[148:151], v[76:79]
    v_add_f32_dpp v250, v250, v250 row_ror:1 row_mask:0xf bank_mask:0xf
    v_add_f32_dpp v251, v251, v251 row_ror:1 row_mask:0xf bank_mask:0xf
    v_mfma_f32_16x16x32_bf16 v[80:83], v[104:107], v[152:155], v[80:83]
    v_add_f32_dpp v252, v252, v252 row_ror:1 row_mask:0xf bank_mask:0xf
    v_add_f32_dpp v253, v253, v253 row_ror:1 row_mask:0xf bank_mask:0xf
    v_mfma_f32_16x16x32_bf16 v[84:87], v[108:111], v[152:155], v[84:87]
    v_add_f32_dpp v254, v254, v254 row_ror:1 row_mask:0xf bank_mask:0xf
    v_add_f32_dpp v255, v255, v255 row_ror:1 row_mask:0xf bank_mask:0xf
    v_mfma_f32_16x16x32_bf16 v[88:91], v[112:115], v[152:155], v[88:91]
    s_waitcnt lgkmcnt(0)
    v_mfma_f32_16x16x32_bf16 v[32:35], v[92:95], v[116:119], v[32:35]
    v_mfma_f32_16x16x32_bf16 v[36:39], v[96:99], v[116:119], v[36:39]
    v_add_u32 v7, s90, v7
    v_add_u32 v11, s90, v11
    v_mfma_f32_16x16x32_bf16 v[40:43], v[100:103], v[116:119], v[40:43]
    ds_read_b128 v[136:139], v7 offset:0
    ds_read_b128 v[140:143], v7 offset:16384
    v_mfma_f32_16x16x32_bf16 v[44:47], v[92:95], v[120:123], v[44:47]
    ds_read_b128 v[144:147], v7 offset:32768
    ds_read_b128 v[148:151], v7 offset:49152
    v_mfma_f32_16x16x32_bf16 v[48:51], v[96:99], v[120:123], v[48:51]
    ds_read_b128 v[152:155], v11
    s_waitcnt vmcnt(12)
    v_mfma_f32_16x16x32_bf16 v[52:55], v[100:103], v[120:123], v[52:55]
    ds_read_b64_tr_b16 v[104:105], v24 offset:3072
    ds_read_b64_tr_b16 v[106:107], v24 offset:4608
    v_mfma_f32_16x16x32_bf16 v[56:59], v[92:95], v[124:127], v[56:59]
    ds_read_b64_tr_b16 v[108:109], v24 offset:3104
    ds_read_b64_tr_b16 v[110:111], v24 offset:4640
    v_mfma_f32_16x16x32_bf16 v[60:63], v[96:99], v[124:127], v[60:63]
    ds_read_b64_tr_b16 v[112:113], v24 offset:3136
    ds_read_b64_tr_b16 v[114:115], v24 offset:4672
    v_mfma_f32_16x16x32_bf16 v[64:67], v[100:103], v[124:127], v[64:67]
    buffer_load_dword v158, off, s[48:51], 0 sc1
    s_add_u32 m0, s80, 0
    s_add_u32 s81, s3, 2
    s_and_b32 s81, s81, 3
    s_mul_i32 s81, s81, 393216
    s_add_u32 s81, s81, 196608
    v_mfma_f32_16x16x32_bf16 v[68:71], v[92:95], v[128:131], v[68:71]
    buffer_load_dwordx4 v14, s[28:31], s81 offen offset:0 lds
    buffer_load_dwordx4 v15, s[28:31], s81 offen offset:1024 lds
    v_mfma_f32_16x16x32_bf16 v[72:75], v[96:99], v[128:131], v[72:75]
    buffer_load_dwordx4 v16, s[28:31], s81 offen offset:2048 lds
    v_mul_f32 v246, 0xbb000000, v246
    v_mfma_f32_16x16x32_bf16 v[76:79], v[100:103], v[128:131], v[76:79]
    v_mul_f32 v247, 0x3b000000, v247
    v_mul_f32 v248, 0xbb000000, v248
    v_mfma_f32_16x16x32_bf16 v[80:83], v[92:95], v[132:135], v[80:83]
    v_mul_f32 v249, 0x3b000000, v249
    v_mul_f32 v250, 0xbb000000, v250
    v_mfma_f32_16x16x32_bf16 v[84:87], v[96:99], v[132:135], v[84:87]
    v_mul_f32 v251, 0x3b000000, v251
    v_mul_f32 v252, 0xbb000000, v252
    v_mfma_f32_16x16x32_bf16 v[88:91], v[100:103], v[132:135], v[88:91]
    v_mul_f32 v253, 0x3b000000, v253
    s_waitcnt lgkmcnt(0)
    v_mfma_f32_16x16x32_bf16 v[32:35], v[104:107], v[136:139], v[32:35]
    v_mfma_f32_16x16x32_bf16 v[36:39], v[108:111], v[136:139], v[36:39]
    ds_read_b128 v[116:119], v8 offset:0
    ds_read_b128 v[120:123], v8 offset:16384
    v_mfma_f32_16x16x32_bf16 v[40:43], v[112:115], v[136:139], v[40:43]
    ds_read_b128 v[124:127], v8 offset:32768
    ds_read_b128 v[128:131], v8 offset:49152
    v_mfma_f32_16x16x32_bf16 v[44:47], v[104:107], v[140:143], v[44:47]
    ds_read_b128 v[132:135], v12
    s_waitcnt vmcnt(13)
    v_mfma_f32_16x16x32_bf16 v[48:51], v[108:111], v[140:143], v[48:51]
    ds_read_b64_tr_b16 v[92:93], v24 offset:6144
    ds_read_b64_tr_b16 v[94:95], v24 offset:7680
    v_mfma_f32_16x16x32_bf16 v[52:55], v[112:115], v[140:143], v[52:55]
    ds_read_b64_tr_b16 v[96:97], v24 offset:6176
    ds_read_b64_tr_b16 v[98:99], v24 offset:7712
    v_mfma_f32_16x16x32_bf16 v[56:59], v[104:107], v[144:147], v[56:59]
    ds_read_b64_tr_b16 v[100:101], v24 offset:6208
    ds_read_b64_tr_b16 v[102:103], v24 offset:7744
    v_mfma_f32_16x16x32_bf16 v[60:63], v[108:111], v[144:147], v[60:63]
    s_add_u32 m0, s80, 3072
    s_add_u32 s81, s3, 2
    s_and_b32 s81, s81, 3
    s_mul_i32 s81, s81, 393216
    s_add_u32 s81, s81, 294912
    buffer_load_dwordx4 v14, s[28:31], s81 offen offset:0 lds
    v_mfma_f32_16x16x32_bf16 v[64:67], v[112:115], v[144:147], v[64:67]
    buffer_load_dwordx4 v15, s[28:31], s81 offen offset:1024 lds
    buffer_load_dwordx4 v16, s[28:31], s81 offen offset:2048 lds
    v_mfma_f32_16x16x32_bf16 v[68:71], v[104:107], v[148:151], v[68:71]
    v_mul_f32 v254, 0xbb000000, v254
    v_mul_f32 v255, 0x3b000000, v255
    v_mfma_f32_16x16x32_bf16 v[72:75], v[108:111], v[148:151], v[72:75]
    v_fma_f32 v247, -v246, v246, v247
    v_max_f32 v247, 0, v247
    v_mfma_f32_16x16x32_bf16 v[76:79], v[112:115], v[148:151], v[76:79]
    v_add_f32 v247, 0x3727c5ac, v247
    v_fma_f32 v249, -v248, v248, v249
    v_mfma_f32_16x16x32_bf16 v[80:83], v[104:107], v[152:155], v[80:83]
    v_max_f32 v249, 0, v249
    v_add_f32 v249, 0x3727c5ac, v249
    v_mfma_f32_16x16x32_bf16 v[84:87], v[108:111], v[152:155], v[84:87]
    v_mfma_f32_16x16x32_bf16 v[88:91], v[112:115], v[152:155], v[88:91]
    s_waitcnt lgkmcnt(0)
    v_mfma_f32_16x16x32_bf16 v[32:35], v[92:95], v[116:119], v[32:35]
    v_mfma_f32_16x16x32_bf16 v[36:39], v[96:99], v[116:119], v[36:39]
    ds_read_b128 v[136:139], v9 offset:0
    ds_read_b128 v[140:143], v9 offset:16384
    v_mfma_f32_16x16x32_bf16 v[40:43], v[100:103], v[116:119], v[40:43]
    ds_read_b128 v[144:147], v9 offset:32768
    ds_read_b128 v[148:151], v9 offset:49152
    v_mfma_f32_16x16x32_bf16 v[44:47], v[92:95], v[120:123], v[44:47]
    ds_read_b128 v[152:155], v13
    s_waitcnt vmcnt(13)
    v_mfma_f32_16x16x32_bf16 v[48:51], v[96:99], v[120:123], v[48:51]
    ds_read_b64_tr_b16 v[104:105], v24 offset:9216
    ds_read_b64_tr_b16 v[106:107], v24 offset:10752
    v_mfma_f32_16x16x32_bf16 v[52:55], v[100:103], v[120:123], v[52:55]
    ds_read_b64_tr_b16 v[108:109], v24 offset:9248
    ds_read_b64_tr_b16 v[110:111], v24 offset:10784
    v_mfma_f32_16x16x32_bf16 v[56:59], v[92:95], v[124:127], v[56:59]
    ds_read_b64_tr_b16 v[112:113], v24 offset:9280
    ds_read_b64_tr_b16 v[114:115], v24 offset:10816
    v_mfma_f32_16x16x32_bf16 v[60:63], v[96:99], v[124:127], v[60:63]
    s_add_u32 m0, s80, 6144
    s_add_u32 s81, s3, 3
    s_and_b32 s81, s81, 3
    s_mul_i32 s81, s81, 393216
    s_add_u32 s81, s81, 196608
    buffer_load_dwordx4 v14, s[28:31], s81 offen offset:0 lds
    v_mfma_f32_16x16x32_bf16 v[64:67], v[100:103], v[124:127], v[64:67]
    buffer_load_dwordx4 v15, s[28:31], s81 offen offset:1024 lds
    buffer_load_dwordx4 v16, s[28:31], s81 offen offset:2048 lds
    v_mfma_f32_16x16x32_bf16 v[68:71], v[92:95], v[128:131], v[68:71]
    v_fma_f32 v251, -v250, v250, v251
    v_max_f32 v251, 0, v251
    v_mfma_f32_16x16x32_bf16 v[72:75], v[96:99], v[128:131], v[72:75]
    v_add_f32 v251, 0x3727c5ac, v251
    v_fma_f32 v253, -v252, v252, v253
    v_mfma_f32_16x16x32_bf16 v[76:79], v[100:103], v[128:131], v[76:79]
    v_max_f32 v253, 0, v253
    v_add_f32 v253, 0x3727c5ac, v253
    v_mfma_f32_16x16x32_bf16 v[80:83], v[92:95], v[132:135], v[80:83]
    v_fma_f32 v255, -v254, v254, v255
    v_max_f32 v255, 0, v255
    v_mfma_f32_16x16x32_bf16 v[84:87], v[96:99], v[132:135], v[84:87]
    v_mfma_f32_16x16x32_bf16 v[88:91], v[100:103], v[132:135], v[88:91]
    s_waitcnt lgkmcnt(0)
    v_mfma_f32_16x16x32_bf16 v[32:35], v[104:107], v[136:139], v[32:35]
    v_mfma_f32_16x16x32_bf16 v[36:39], v[108:111], v[136:139], v[36:39]
    v_add_u32 v8, s87, v8
    v_add_u32 v12, s87, v12
    v_mfma_f32_16x16x32_bf16 v[40:43], v[112:115], v[136:139], v[40:43]
    ds_read_b128 v[116:119], v8 offset:0
    ds_read_b128 v[120:123], v8 offset:16384
    v_mfma_f32_16x16x32_bf16 v[44:47], v[104:107], v[140:143], v[44:47]
    ds_read_b128 v[124:127], v8 offset:32768
    ds_read_b128 v[128:131], v8 offset:49152
    v_mfma_f32_16x16x32_bf16 v[48:51], v[108:111], v[140:143], v[48:51]
    ds_read_b128 v[132:135], v12
    s_waitcnt vmcnt(13)
    v_mfma_f32_16x16x32_bf16 v[52:55], v[112:115], v[140:143], v[52:55]
    ds_read_b64_tr_b16 v[92:93], v24 offset:12288
    ds_read_b64_tr_b16 v[94:95], v24 offset:13824
    v_mfma_f32_16x16x32_bf16 v[56:59], v[104:107], v[144:147], v[56:59]
    ds_read_b64_tr_b16 v[96:97], v24 offset:12320
    ds_read_b64_tr_b16 v[98:99], v24 offset:13856
    v_mfma_f32_16x16x32_bf16 v[60:63], v[108:111], v[144:147], v[60:63]
    ds_read_b64_tr_b16 v[100:101], v24 offset:12352
    ds_read_b64_tr_b16 v[102:103], v24 offset:13888
    v_mfma_f32_16x16x32_bf16 v[64:67], v[112:115], v[144:147], v[64:67]
    s_add_u32 m0, s80, 9216
    s_add_u32 s81, s3, 3
    s_and_b32 s81, s81, 3
    s_mul_i32 s81, s81, 393216
    s_add_u32 s81, s81, 294912
    buffer_load_dwordx4 v14, s[28:31], s81 offen offset:0 lds
    v_mfma_f32_16x16x32_bf16 v[68:71], v[104:107], v[148:151], v[68:71]
    buffer_load_dwordx4 v15, s[28:31], s81 offen offset:1024 lds
    buffer_load_dwordx4 v16, s[28:31], s81 offen offset:2048 lds
    v_mfma_f32_16x16x32_bf16 v[72:75], v[108:111], v[148:151], v[72:75]
    v_add_f32 v255, 0x3727c5ac, v255
    v_rsq_f32 v247, v247
    v_mfma_f32_16x16x32_bf16 v[76:79], v[112:115], v[148:151], v[76:79]
    v_rsq_f32 v249, v249
    v_rsq_f32 v251, v251
    v_mfma_f32_16x16x32_bf16 v[80:83], v[104:107], v[152:155], v[80:83]
    v_rsq_f32 v253, v253
    v_rsq_f32 v255, v255
    v_mfma_f32_16x16x32_bf16 v[84:87], v[108:111], v[152:155], v[84:87]
    ds_write_b64 v30, v[246:247] offset:0
    ds_write_b64 v30, v[248:249] offset:128
    v_mfma_f32_16x16x32_bf16 v[88:91], v[112:115], v[152:155], v[88:91]
    s_waitcnt lgkmcnt(0)
    v_mfma_f32_16x16x32_bf16 v[32:35], v[92:95], v[116:119], v[32:35]
    v_mfma_f32_16x16x32_bf16 v[36:39], v[96:99], v[116:119], v[36:39]
    v_add_u32 v9, s87, v9
    v_add_u32 v13, s87, v13
    v_mfma_f32_16x16x32_bf16 v[40:43], v[100:103], v[116:119], v[40:43]
    ds_read_b128 v[136:139], v9 offset:0
    ds_read_b128 v[140:143], v9 offset:16384
    v_mfma_f32_16x16x32_bf16 v[44:47], v[92:95], v[120:123], v[44:47]
    ds_read_b128 v[144:147], v9 offset:32768
    ds_read_b128 v[148:151], v9 offset:49152
    v_mfma_f32_16x16x32_bf16 v[48:51], v[96:99], v[120:123], v[48:51]
    ds_read_b128 v[152:155], v13
    s_waitcnt vmcnt(13)
    v_mfma_f32_16x16x32_bf16 v[52:55], v[100:103], v[120:123], v[52:55]
    ds_read_b64_tr_b16 v[104:105], v24 offset:15360
    ds_read_b64_tr_b16 v[106:107], v24 offset:16896
    v_mfma_f32_16x16x32_bf16 v[56:59], v[92:95], v[124:127], v[56:59]
    ds_read_b64_tr_b16 v[108:109], v24 offset:15392
    ds_read_b64_tr_b16 v[110:111], v24 offset:16928
    v_mfma_f32_16x16x32_bf16 v[60:63], v[96:99], v[124:127], v[60:63]
    ds_read_b64_tr_b16 v[112:113], v24 offset:15424
    ds_read_b64_tr_b16 v[114:115], v24 offset:16960
    v_mfma_f32_16x16x32_bf16 v[64:67], v[100:103], v[124:127], v[64:67]
    v_lshlrev_b32 v5, 6, v1
    s_lshr_b32 s84, s2, 3
    s_lshl_b32 s84, s84, 2
    s_add_u32 s84, s84, s64
    s_mul_i32 s85, s84, 11264
    s_lshl_b32 s84, s84, 12
    s_mov_b32 m0, 160384
    s_mov_b64 exec, 0xf
    buffer_load_dword v5, s[32:35], s84 offen offset:384 lds
    s_mov_b64 exec, 0x7ff
    buffer_load_dword v5, s[40:43], s85 offen offset:384 lds
    s_mov_b64 exec, -1
    ds_write_b64 v30, v[250:251] offset:256
    v_mfma_f32_16x16x32_bf16 v[68:71], v[92:95], v[128:131], v[68:71]
    ds_write_b64 v30, v[252:253] offset:384
    ds_write_b64 v30, v[254:255] offset:512
    v_mfma_f32_16x16x32_bf16 v[72:75], v[96:99], v[128:131], v[72:75]
    v_mfma_f32_16x16x32_bf16 v[76:79], v[100:103], v[128:131], v[76:79]
    v_mfma_f32_16x16x32_bf16 v[80:83], v[92:95], v[132:135], v[80:83]
    v_mfma_f32_16x16x32_bf16 v[84:87], v[96:99], v[132:135], v[84:87]
    v_mfma_f32_16x16x32_bf16 v[88:91], v[100:103], v[132:135], v[88:91]
    s_waitcnt lgkmcnt(0)
    v_mfma_f32_16x16x32_bf16 v[32:35], v[104:107], v[136:139], v[32:35]
    v_mfma_f32_16x16x32_bf16 v[36:39], v[108:111], v[136:139], v[36:39]
    v_add_u32 v8, s88, v8
    v_add_u32 v12, s88, v12
    v_mfma_f32_16x16x32_bf16 v[40:43], v[112:115], v[136:139], v[40:43]
    ds_read_b128 v[116:119], v8 offset:0
    ds_read_b128 v[120:123], v8 offset:16384
    v_mfma_f32_16x16x32_bf16 v[44:47], v[104:107], v[140:143], v[44:47]
    ds_read_b128 v[124:127], v8 offset:32768
    ds_read_b128 v[128:131], v8 offset:49152
    v_mfma_f32_16x16x32_bf16 v[48:51], v[108:111], v[140:143], v[48:51]
    ds_read_b128 v[132:135], v12
    s_waitcnt vmcnt(11)
    v_mfma_f32_16x16x32_bf16 v[52:55], v[112:115], v[140:143], v[52:55]
    ds_read_b64_tr_b16 v[92:93], v24 offset:0
    ds_read_b64_tr_b16 v[94:95], v24 offset:1536
    v_mfma_f32_16x16x32_bf16 v[56:59], v[104:107], v[144:147], v[56:59]
    ds_read_b64_tr_b16 v[96:97], v24 offset:32
    ds_read_b64_tr_b16 v[98:99], v24 offset:1568
    v_mfma_f32_16x16x32_bf16 v[60:63], v[108:111], v[144:147], v[60:63]
    ds_read_b64_tr_b16 v[100:101], v24 offset:64
    ds_read_b64_tr_b16 v[102:103], v24 offset:1600
    v_mfma_f32_16x16x32_bf16 v[64:67], v[112:115], v[144:147], v[64:67]
    s_add_u32 m0, s80, 12288
    s_add_u32 s81, s3, 0
    s_and_b32 s81, s81, 3
    s_lshl_b32 s81, s81, 15
    s_add_u32 s81, s81, s89
    buffer_load_dwordx4 v20, s[32:35], s81 offen offset:0 lds
    v_mfma_f32_16x16x32_bf16 v[68:71], v[104:107], v[148:151], v[68:71]
    buffer_load_dwordx4 v21, s[32:35], s81 offen offset:1024 lds
    buffer_load_dwordx4 v22, s[32:35], s81 offen offset:2048 lds
    v_mfma_f32_16x16x32_bf16 v[72:75], v[108:111], v[148:151], v[72:75]
    buffer_load_dwordx4 v23, s[32:35], s81 offen offset:3072 lds
    v_mfma_f32_16x16x32_bf16 v[76:79], v[112:115], v[148:151], v[76:79]
    v_mfma_f32_16x16x32_bf16 v[80:83], v[104:107], v[152:155], v[80:83]
    v_mfma_f32_16x16x32_bf16 v[84:87], v[108:111], v[152:155], v[84:87]
    v_mfma_f32_16x16x32_bf16 v[88:91], v[112:115], v[152:155], v[88:91]
    s_waitcnt lgkmcnt(0)
    v_mfma_f32_16x16x32_bf16 v[32:35], v[92:95], v[116:119], v[32:35]
    v_mfma_f32_16x16x32_bf16 v[36:39], v[96:99], v[116:119], v[36:39]
    v_add_u32 v9, s88, v9
    v_add_u32 v13, s88, v13
    v_mfma_f32_16x16x32_bf16 v[40:43], v[100:103], v[116:119], v[40:43]
    ds_read_b128 v[136:139], v9 offset:0
    ds_read_b128 v[140:143], v9 offset:16384
    v_mfma_f32_16x16x32_bf16 v[44:47], v[92:95], v[120:123], v[44:47]
    ds_read_b128 v[144:147], v9 offset:32768
    ds_read_b128 v[148:151], v9 offset:49152
    v_mfma_f32_16x16x32_bf16 v[48:51], v[96:99], v[120:123], v[48:51]
    ds_read_b128 v[152:155], v13
    s_waitcnt vmcnt(12)
    v_mfma_f32_16x16x32_bf16 v[52:55], v[100:103], v[120:123], v[52:55]
    ds_read_b64_tr_b16 v[104:105], v24 offset:3072
    ds_read_b64_tr_b16 v[106:107], v24 offset:4608
    v_mfma_f32_16x16x32_bf16 v[56:59], v[92:95], v[124:127], v[56:59]
    ds_read_b64_tr_b16 v[108:109], v24 offset:3104
    ds_read_b64_tr_b16 v[110:111], v24 offset:4640
    v_mfma_f32_16x16x32_bf16 v[60:63], v[96:99], v[124:127], v[60:63]
    ds_read_b64_tr_b16 v[112:113], v24 offset:3136
    ds_read_b64_tr_b16 v[114:115], v24 offset:4672
    v_mfma_f32_16x16x32_bf16 v[64:67], v[100:103], v[124:127], v[64:67]
    v_readfirstlane_b32 s84, v158
    s_nop 1
    s_sub_u32 s84, s84, 1
    s_or_b32 s84, s84, s64
    s_cmp_lg_u32 s84, 0
    s_cbranch_scc1 NOPUB
    s_mov_b64 exec, 1
    buffer_store_dword v28, off, s[60:63], s92 offset:4 sc1
    s_mov_b64 exec, -1
NOPUB:
    s_add_u32 m0, s80, 16384
    s_add_u32 s81, s3, 0
    s_and_b32 s81, s81, 3
    s_mul_i32 s81, s81, 88064
    v_mfma_f32_16x16x32_bf16 v[68:71], v[92:95], v[128:131], v[68:71]
    buffer_load_dwordx4 v17, s[36:39], s81 offen offset:0 lds
    buffer_load_dwordx4 v18, s[36:39], s81 offen offset:1024 lds
    v_mfma_f32_16x16x32_bf16 v[72:75], v[96:99], v[128:131], v[72:75]
    buffer_load_dwordx4 v19, s[36:39], s81 offen offset:2048 lds
    v_mfma_f32_16x16x32_bf16 v[76:79], v[100:103], v[128:131], v[76:79]
    v_mfma_f32_16x16x32_bf16 v[80:83], v[92:95], v[132:135], v[80:83]
    v_mfma_f32_16x16x32_bf16 v[84:87], v[96:99], v[132:135], v[84:87]
    v_mfma_f32_16x16x32_bf16 v[88:91], v[100:103], v[132:135], v[88:91]
    s_waitcnt lgkmcnt(0)
    v_mfma_f32_16x16x32_bf16 v[32:35], v[104:107], v[136:139], v[32:35]
    v_mfma_f32_16x16x32_bf16 v[36:39], v[108:111], v[136:139], v[36:39]
    v_add_u32 v8, s90, v8
    v_add_u32 v12, s90, v12
    v_mfma_f32_16x16x32_bf16 v[40:43], v[112:115], v[136:139], v[40:43]
    ds_read_b128 v[116:119], v8 offset:0
    ds_read_b128 v[120:123], v8 offset:16384
    v_mfma_f32_16x16x32_bf16 v[44:47], v[104:107], v[140:143], v[44:47]
    ds_read_b128 v[124:127], v8 offset:32768
    ds_read_b128 v[128:131], v8 offset:49152
    v_mfma_f32_16x16x32_bf16 v[48:51], v[108:111], v[140:143], v[48:51]
    ds_read_b128 v[132:135], v12
    s_waitcnt vmcnt(12)
    v_mfma_f32_16x16x32_bf16 v[52:55], v[112:115], v[140:143], v[52:55]
    ds_read_b64_tr_b16 v[92:93], v24 offset:6144
    ds_read_b64_tr_b16 v[94:95], v24 offset:7680
    v_mfma_f32_16x16x32_bf16 v[56:59], v[104:107], v[144:147], v[56:59]
    ds_read_b64_tr_b16 v[96:97], v24 offset:6176
    ds_read_b64_tr_b16 v[98:99], v24 offset:7712
    v_mfma_f32_16x16x32_bf16 v[60:63], v[108:111], v[144:147], v[60:63]
    ds_read_b64_tr_b16 v[100:101], v24 offset:6208
    ds_read_b64_tr_b16 v[102:103], v24 offset:7744
    v_mfma_f32_16x16x32_bf16 v[64:67], v[112:115], v[144:147], v[64:67]
    s_add_u32 m0, s80, 0
    s_add_u32 s81, s3, 0
    s_and_b32 s81, s81, 3
    s_mul_i32 s81, s81, 88064
    s_add_u32 s81, s81, 352256
    buffer_load_dwordx4 v17, s[36:39], s81 offen offset:0 lds
    v_mfma_f32_16x16x32_bf16 v[68:71], v[104:107], v[148:151], v[68:71]
    buffer_load_dwordx4 v18, s[36:39], s81 offen offset:1024 lds
    buffer_load_dwordx4 v19, s[36:39], s81 offen offset:2048 lds
    v_mfma_f32_16x16x32_bf16 v[72:75], v[108:111], v[148:151], v[72:75]
    v_mfma_f32_16x16x32_bf16 v[76:79], v[112:115], v[148:151], v[76:79]
    v_mfma_f32_16x16x32_bf16 v[80:83], v[104:107], v[152:155], v[80:83]
    v_mfma_f32_16x16x32_bf16 v[84:87], v[108:111], v[152:155], v[84:87]
    v_mfma_f32_16x16x32_bf16 v[88:91], v[112:115], v[152:155], v[88:91]
    s_waitcnt lgkmcnt(0)
    v_mfma_f32_16x16x32_bf16 v[32:35], v[92:95], v[116:119], v[32:35]
    v_mfma_f32_16x16x32_bf16 v[36:39], v[96:99], v[116:119], v[36:39]
    v_add_u32 v9, s90, v9
    v_add_u32 v13, s90, v13
    v_mfma_f32_16x16x32_bf16 v[40:43], v[100:103], v[116:119], v[40:43]
    ds_read_b128 v[136:139], v9 offset:0
    ds_read_b128 v[140:143], v9 offset:16384
    v_mfma_f32_16x16x32_bf16 v[44:47], v[92:95], v[120:123], v[44:47]
    ds_read_b128 v[144:147], v9 offset:32768
    ds_read_b128 v[148:151], v9 offset:49152
    v_mfma_f32_16x16x32_bf16 v[48:51], v[96:99], v[120:123], v[48:51]
    ds_read_b128 v[152:155], v13
    s_waitcnt vmcnt(12)
    v_mfma_f32_16x16x32_bf16 v[52:55], v[100:103], v[120:123], v[52:55]
    ds_read_b64_tr_b16 v[104:105], v24 offset:9216
    ds_read_b64_tr_b16 v[106:107], v24 offset:10752
    v_mfma_f32_16x16x32_bf16 v[56:59], v[92:95], v[124:127], v[56:59]
    ds_read_b64_tr_b16 v[108:109], v24 offset:9248
    ds_read_b64_tr_b16 v[110:111], v24 offset:10784
    v_mfma_f32_16x16x32_bf16 v[60:63], v[96:99], v[124:127], v[60:63]
    ds_read_b64_tr_b16 v[112:113], v24 offset:9280
    ds_read_b64_tr_b16 v[114:115], v24 offset:10816
    v_mfma_f32_16x16x32_bf16 v[64:67], v[100:103], v[124:127], v[64:67]
    s_add_u32 m0, s80, 3072
    s_add_u32 s81, s3, 0
    s_and_b32 s81, s81, 3
    s_mul_i32 s81, s81, 88064
    s_add_u32 s81, s81, 704512
    buffer_load_dwordx4 v17, s[36:39], s81 offen offset:0 lds
    v_mfma_f32_16x16x32_bf16 v[68:71], v[92:95], v[128:131], v[68:71]
    buffer_load_dwordx4 v18, s[36:39], s81 offen offset:1024 lds
    buffer_load_dwordx4 v19, s[36:39], s81 offen offset:2048 lds
    v_mfma_f32_16x16x32_bf16 v[72:75], v[96:99], v[128:131], v[72:75]
    v_mfma_f32_16x16x32_bf16 v[76:79], v[100:103], v[128:131], v[76:79]
    v_mfma_f32_16x16x32_bf16 v[80:83], v[92:95], v[132:135], v[80:83]
    v_mfma_f32_16x16x32_bf16 v[84:87], v[96:99], v[132:135], v[84:87]
    v_mfma_f32_16x16x32_bf16 v[88:91], v[100:103], v[132:135], v[88:91]
    s_waitcnt lgkmcnt(0)
    s_barrier
    v_mfma_f32_16x16x32_bf16 v[32:35], v[104:107], v[136:139], v[32:35]
    v_mfma_f32_16x16x32_bf16 v[36:39], v[108:111], v[136:139], v[36:39]
    s_add_u32 m0, s80, 6144
    s_add_u32 s81, s3, 0
    s_and_b32 s81, s81, 3
    s_mul_i32 s81, s81, 88064
    s_add_u32 s81, s81, 1056768
    buffer_load_dwordx4 v17, s[36:39], s81 offen offset:0 lds
    v_mfma_f32_16x16x32_bf16 v[40:43], v[112:115], v[136:139], v[40:43]
    buffer_load_dwordx4 v18, s[36:39], s81 offen offset:1024 lds
    buffer_load_dwordx4 v19, s[36:39], s81 offen offset:2048 lds
    v_mfma_f32_16x16x32_bf16 v[44:47], v[104:107], v[140:143], v[44:47]
    v_mfma_f32_16x16x32_bf16 v[48:51], v[108:111], v[140:143], v[48:51]
    v_mfma_f32_16x16x32_bf16 v[52:55], v[112:115], v[140:143], v[52:55]
    v_mfma_f32_16x16x32_bf16 v[56:59], v[104:107], v[144:147], v[56:59]
    v_mfma_f32_16x16x32_bf16 v[60:63], v[108:111], v[144:147], v[60:63]
    v_mfma_f32_16x16x32_bf16 v[64:67], v[112:115], v[144:147], v[64:67]
    v_mfma_f32_16x16x32_bf16 v[68:71], v[104:107], v[148:151], v[68:71]
    v_mfma_f32_16x16x32_bf16 v[72:75], v[108:111], v[148:151], v[72:75]
    v_mfma_f32_16x16x32_bf16 v[76:79], v[112:115], v[148:151], v[76:79]
    v_mfma_f32_16x16x32_bf16 v[80:83], v[104:107], v[152:155], v[80:83]
    v_mfma_f32_16x16x32_bf16 v[84:87], v[108:111], v[152:155], v[84:87]
    v_mfma_f32_16x16x32_bf16 v[88:91], v[112:115], v[152:155], v[88:91]
    s_mov_b32 s87, 0x05040100
    s_mov_b32 s88, 0x07060302
    s_mul_i32 s90, s64, 360448
    s_mul_i32 s84, s3, 98304
    s_add_u32 s90, s90, s84
    buffer_load_dword v11, off, s[48:51], 0 sc1
    v_bfe_u32 v13, v1, 4, 3
    v_mul_u32_u24 v13, 128, v13
    buffer_load_dwordx4 v[238:241], v31, s[24:27], 0 offen
    buffer_load_dwordx4 v[242:245], v31, s[24:27], 0 offen offset:64
    ds_read_b64 v[104:105], v29 offset:0
    ds_read_b64 v[106:107], v29 offset:128
    ds_read_b64 v[108:109], v29 offset:256
    ds_read_b64 v[110:111], v29 offset:384
    ds_read_b64 v[112:113], v29 offset:512
    v_mov_b32_dpp v92, v32 row_newbcast:0 row_mask:0xf bank_mask:0xf
    s_waitcnt vmcnt(15)
    v_mov_b32_dpp v93, v33 row_newbcast:0 row_mask:0xf bank_mask:0xf
    v_mov_b32_dpp v94, v34 row_newbcast:0 row_mask:0xf bank_mask:0xf
    v_mov_b32_dpp v95, v35 row_newbcast:0 row_mask:0xf bank_mask:0xf
    v_mov_b32_dpp v96, v36 row_newbcast:0 row_mask:0xf bank_mask:0xf
    v_mov_b32_dpp v97, v37 row_newbcast:0 row_mask:0xf bank_mask:0xf
    v_mov_b32_dpp v98, v38 row_newbcast:0 row_mask:0xf bank_mask:0xf
    ds_read_b64_tr_b16 a[0:1], v26 offset:12288
    v_mov_b32_dpp v99, v39 row_newbcast:0 row_mask:0xf bank_mask:0xf
    v_mov_b32_dpp v100, v40 row_newbcast:0 row_mask:0xf bank_mask:0xf
    v_mov_b32_dpp v101, v41 row_newbcast:0 row_mask:0xf bank_mask:0xf
    v_mov_b32_dpp v102, v42 row_newbcast:0 row_mask:0xf bank_mask:0xf
    v_mov_b32_dpp v103, v43 row_newbcast:0 row_mask:0xf bank_mask:0xf
    s_mul_i32 s84, s64, 11520
    ds_read_b64_tr_b16 a[2:3], v26 offset:14336
    v_mul_u32_u24 v116, 48, v2
    v_lshl_add_u32 v116, v3, 3, v116
    v_add_u32 v116, s84, v116
    s_waitcnt lgkmcnt(6)
    v_pk_fma_f32 v[32:33], v[92:93], v[104:105], v[32:33] op_sel:[0,0,0] op_sel_hi:[1,0,1]
    v_pk_fma_f32 v[34:35], v[94:95], v[104:105], v[34:35] op_sel:[0,0,0] op_sel_hi:[1,0,1]
    v_pk_fma_f32 v[36:37], v[96:97], v[104:105], v[36:37] op_sel:[0,0,0] op_sel_hi:[1,0,1]
    ds_read_b64_tr_b16 a[4:5], v26 offset:12296
    v_pk_fma_f32 v[38:39], v[98:99], v[104:105], v[38:39] op_sel:[0,0,0] op_sel_hi:[1,0,1]
    v_pk_fma_f32 v[40:41], v[100:101], v[104:105], v[40:41] op_sel:[0,0,0] op_sel_hi:[1,0,1]
    v_pk_fma_f32 v[42:43], v[102:103], v[104:105], v[42:43] op_sel:[0,0,0] op_sel_hi:[1,0,1]
    v_pk_mul_f32 v[32:33], v[32:33], v[104:105] op_sel:[0,1] op_sel_hi:[1,1]
    v_pk_mul_f32 v[34:35], v[34:35], v[104:105] op_sel:[0,1] op_sel_hi:[1,1]
    v_pk_mul_f32 v[36:37], v[36:37], v[104:105] op_sel:[0,1] op_sel_hi:[1,1]
    ds_read_b64_tr_b16 a[6:7], v26 offset:14344
    v_pk_mul_f32 v[38:39], v[38:39], v[104:105] op_sel:[0,1] op_sel_hi:[1,1]
    v_pk_mul_f32 v[40:41], v[40:41], v[104:105] op_sel:[0,1] op_sel_hi:[1,1]
    v_pk_mul_f32 v[42:43], v[42:43], v[104:105] op_sel:[0,1] op_sel_hi:[1,1]
    v_cvt_pk_bf16_f32 v120, v32, v33
    v_cvt_pk_bf16_f32 v121, v34, v35
    ds_write_b64 v116, v[120:121] offset:0
    ds_read_b64_tr_b16 a[8:9], v27 offset:12288
    v_cvt_pk_bf16_f32 v122, v36, v37
    v_cvt_pk_bf16_f32 v123, v38, v39
    ds_write_b64 v116, v[122:123] offset:3840
    v_cvt_pk_bf16_f32 v124, v40, v41
    v_cvt_pk_bf16_f32 v125, v42, v43
    ds_write_b64 v116, v[124:125] offset:7680
    ds_read_b64_tr_b16 a[10:11], v27 offset:14336
    s_waitcnt lgkmcnt(12)
    v_pk_fma_f32 v[44:45], v[92:93], v[106:107], v[44:45] op_sel:[0,0,0] op_sel_hi:[1,0,1]
    v_pk_fma_f32 v[46:47], v[94:95], v[106:107], v[46:47] op_sel:[0,0,0] op_sel_hi:[1,0,1]
    v_pk_fma_f32 v[48:49], v[96:97], v[106:107], v[48:49] op_sel:[0,0,0] op_sel_hi:[1,0,1]
    v_pk_fma_f32 v[50:51], v[98:99], v[106:107], v[50:51] op_sel:[0,0,0] op_sel_hi:[1,0,1]
    v_pk_fma_f32 v[52:53], v[100:101], v[106:107], v[52:53] op_sel:[0,0,0] op_sel_hi:[1,0,1]
    v_pk_fma_f32 v[54:55], v[102:103], v[106:107], v[54:55] op_sel:[0,0,0] op_sel_hi:[1,0,1]
    ds_read_b64_tr_b16 a[12:13], v27 offset:12296
    v_pk_mul_f32 v[44:45], v[44:45], v[106:107] op_sel:[0,1] op_sel_hi:[1,1]
    v_pk_mul_f32 v[46:47], v[46:47], v[106:107] op_sel:[0,1] op_sel_hi:[1,1]
    v_pk_mul_f32 v[48:49], v[48:49], v[106:107] op_sel:[0,1] op_sel_hi:[1,1]
    v_pk_mul_f32 v[50:51], v[50:51], v[106:107] op_sel:[0,1] op_sel_hi:[1,1]
    v_pk_mul_f32 v[52:53], v[52:53], v[106:107] op_sel:[0,1] op_sel_hi:[1,1]
    v_pk_mul_f32 v[54:55], v[54:55], v[106:107] op_sel:[0,1] op_sel_hi:[1,1]
    ds_read_b64_tr_b16 a[14:15], v27 offset:14344
    v_cvt_pk_bf16_f32 v126, v44, v45
    v_cvt_pk_bf16_f32 v127, v46, v47
    ds_write_b64 v116, v[126:127] offset:768
    v_cvt_pk_bf16_f32 v128, v48, v49
    v_cvt_pk_bf16_f32 v129, v50, v51
    ds_write_b64 v116, v[128:129] offset:4608
    s_waitcnt lgkmcnt(2)
    s_add_u32 m0, s80, 9216
    s_add_u32 s81, s3, 1
    s_and_b32 s81, s81, 3
    s_lshl_b32 s81, s81, 15
    s_add_u32 s81, s81, s89
    v_cvt_pk_bf16_f32 v130, v52, v53
    v_cvt_pk_bf16_f32 v131, v54, v55
    ds_write_b64 v116, v[130:131] offset:8448
    v_pk_fma_f32 v[56:57], v[92:93], v[108:109], v[56:57] op_sel:[0,0,0] op_sel_hi:[1,0,1]
    v_pk_fma_f32 v[58:59], v[94:95], v[108:109], v[58:59] op_sel:[0,0,0] op_sel_hi:[1,0,1]
    v_pk_fma_f32 v[60:61], v[96:97], v[108:109], v[60:61] op_sel:[0,0,0] op_sel_hi:[1,0,1]
    buffer_load_dwordx4 v20, s[32:35], s81 offen offset:0 lds
    v_pk_fma_f32 v[62:63], v[98:99], v[108:109], v[62:63] op_sel:[0,0,0] op_sel_hi:[1,0,1]
    v_pk_fma_f32 v[64:65], v[100:101], v[108:109], v[64:65] op_sel:[0,0,0] op_sel_hi:[1,0,1]
    v_pk_fma_f32 v[66:67], v[102:103], v[108:109], v[66:67] op_sel:[0,0,0] op_sel_hi:[1,0,1]
    v_pk_mul_f32 v[56:57], v[56:57], v[108:109] op_sel:[0,1] op_sel_hi:[1,1]
    v_pk_mul_f32 v[58:59], v[58:59], v[108:109] op_sel:[0,1] op_sel_hi:[1,1]
    v_pk_mul_f32 v[60:61], v[60:61], v[108:109] op_sel:[0,1] op_sel_hi:[1,1]
    buffer_load_dwordx4 v21, s[32:35], s81 offen offset:1024 lds
    v_pk_mul_f32 v[62:63], v[62:63], v[108:109] op_sel:[0,1] op_sel_hi:[1,1]
    v_pk_mul_f32 v[64:65], v[64:65], v[108:109] op_sel:[0,1] op_sel_hi:[1,1]
    v_pk_mul_f32 v[66:67], v[66:67], v[108:109] op_sel:[0,1] op_sel_hi:[1,1]
    v_cvt_pk_bf16_f32 v120, v56, v57
    v_cvt_pk_bf16_f32 v121, v58, v59
    ds_write_b64 v116, v[120:121] offset:1536
    buffer_load_dwordx4 v22, s[32:35], s81 offen offset:2048 lds
    v_cvt_pk_bf16_f32 v122, v60, v61
    v_cvt_pk_bf16_f32 v123, v62, v63
    ds_write_b64 v116, v[122:123] offset:5376
    v_cvt_pk_bf16_f32 v124, v64, v65
    v_cvt_pk_bf16_f32 v125, v66, v67
    ds_write_b64 v116, v[124:125] offset:9216
    buffer_load_dwordx4 v23, s[32:35], s81 offen offset:3072 lds
    v_pk_fma_f32 v[68:69], v[92:93], v[110:111], v[68:69] op_sel:[0,0,0] op_sel_hi:[1,0,1]
    v_pk_fma_f32 v[70:71], v[94:95], v[110:111], v[70:71] op_sel:[0,0,0] op_sel_hi:[1,0,1]
    v_pk_fma_f32 v[72:73], v[96:97], v[110:111], v[72:73] op_sel:[0,0,0] op_sel_hi:[1,0,1]
    v_pk_fma_f32 v[74:75], v[98:99], v[110:111], v[74:75] op_sel:[0,0,0] op_sel_hi:[1,0,1]
    v_pk_fma_f32 v[76:77], v[100:101], v[110:111], v[76:77] op_sel:[0,0,0] op_sel_hi:[1,0,1]
    v_pk_fma_f32 v[78:79], v[102:103], v[110:111], v[78:79] op_sel:[0,0,0] op_sel_hi:[1,0,1]
    s_waitcnt vmcnt(16)
    v_pk_mul_f32 v[68:69], v[68:69], v[110:111] op_sel:[0,1] op_sel_hi:[1,1]
    v_pk_mul_f32 v[70:71], v[70:71], v[110:111] op_sel:[0,1] op_sel_hi:[1,1]
    v_pk_mul_f32 v[72:73], v[72:73], v[110:111] op_sel:[0,1] op_sel_hi:[1,1]
    v_pk_mul_f32 v[74:75], v[74:75], v[110:111] op_sel:[0,1] op_sel_hi:[1,1]
    v_pk_mul_f32 v[76:77], v[76:77], v[110:111] op_sel:[0,1] op_sel_hi:[1,1]
    v_pk_mul_f32 v[78:79], v[78:79], v[110:111] op_sel:[0,1] op_sel_hi:[1,1]
    ds_read_b64_tr_b16 a[64:65], v25 offset:16384
    v_cvt_pk_bf16_f32 v126, v68, v69
    v_cvt_pk_bf16_f32 v127, v70, v71
    ds_write_b64 v116, v[126:127] offset:2304
    v_cvt_pk_bf16_f32 v128, v72, v73
    v_cvt_pk_bf16_f32 v129, v74, v75
    ds_write_b64 v116, v[128:129] offset:6144
    ds_read_b64_tr_b16 a[66:67], v25 offset:17920
    v_cvt_pk_bf16_f32 v130, v76, v77
    v_cvt_pk_bf16_f32 v131, v78, v79
    ds_write_b64 v116, v[130:131] offset:9984
    v_pk_fma_f32 v[80:81], v[92:93], v[112:113], v[80:81] op_sel:[0,0,0] op_sel_hi:[1,0,1]
    v_pk_fma_f32 v[82:83], v[94:95], v[112:113], v[82:83] op_sel:[0,0,0] op_sel_hi:[1,0,1]
    v_pk_fma_f32 v[84:85], v[96:97], v[112:113], v[84:85] op_sel:[0,0,0] op_sel_hi:[1,0,1]
    ds_read_b64_tr_b16 a[68:69], v25 offset:16392
    v_pk_fma_f32 v[86:87], v[98:99], v[112:113], v[86:87] op_sel:[0,0,0] op_sel_hi:[1,0,1]
    v_pk_fma_f32 v[88:89], v[100:101], v[112:113], v[88:89] op_sel:[0,0,0] op_sel_hi:[1,0,1]
    v_pk_fma_f32 v[90:91], v[102:103], v[112:113], v[90:91] op_sel:[0,0,0] op_sel_hi:[1,0,1]
    v_pk_mul_f32 v[80:81], v[80:81], v[112:113] op_sel:[0,1] op_sel_hi:[1,1]
    v_pk_mul_f32 v[82:83], v[82:83], v[112:113] op_sel:[0,1] op_sel_hi:[1,1]
    v_pk_mul_f32 v[84:85], v[84:85], v[112:113] op_sel:[0,1] op_sel_hi:[1,1]
    ds_read_b64_tr_b16 a[70:71], v25 offset:17928
    v_pk_mul_f32 v[86:87], v[86:87], v[112:113] op_sel:[0,1] op_sel_hi:[1,1]
    v_pk_mul_f32 v[88:89], v[88:89], v[112:113] op_sel:[0,1] op_sel_hi:[1,1]
    v_pk_mul_f32 v[90:91], v[90:91], v[112:113] op_sel:[0,1] op_sel_hi:[1,1]
    v_cvt_pk_bf16_f32 v120, v80, v81
    v_cvt_pk_bf16_f32 v121, v82, v83
    ds_write_b64 v116, v[120:121] offset:3072
    ds_read_b64_tr_b16 a[72:73], v25 offset:16400
    v_cvt_pk_bf16_f32 v122, v84, v85
    v_cvt_pk_bf16_f32 v123, v86, v87
    ds_write_b64 v116, v[122:123] offset:6912
    v_cvt_pk_bf16_f32 v124, v88, v89
    v_cvt_pk_bf16_f32 v125, v90, v91
    ds_write_b64 v116, v[124:125] offset:10752
    ds_read_b64_tr_b16 a[74:75], v25 offset:17936
    s_waitcnt lgkmcnt(0)
    s_barrier
    buffer_load_dword v224, v13, s[60:63], s82 offen offset:4 sc1
    v_lshrrev_b32 v221, 4, v1
    s_mul_i32 s84, s64, 3840
    v_mul_u32_u24 v220, 48, v221
    v_add_u32 v220, s84, v220
    s_add_u32 m0, s80, 13312
    s_add_u32 s81, s3, 2
    s_and_b32 s81, s81, 3
    s_lshl_b32 s81, s81, 15
    s_add_u32 s81, s81, s89
    ds_read_b128 v[32:35], v220 offset:768
    ds_read_b128 v[36:39], v220 offset:784
    ds_read_b128 v[40:43], v220 offset:16128
    ds_read_b128 v[44:47], v220 offset:16144
    ds_read_b128 v[48:51], v220 offset:16032
    ds_read_b128 v[52:55], v220 offset:16048
    buffer_load_dwordx4 v20, s[32:35], s81 offen offset:0 lds
    ds_read_b128 v[56:59], v220 offset:15936
    ds_read_b128 v[60:63], v220 offset:15952
    ds_read_b128 v[64:67], v220 offset:15840
    ds_read_b128 v[68:71], v220 offset:15856
    ds_read_b128 v[72:75], v220 offset:15744
    ds_read_b128 v[76:79], v220 offset:15760
    buffer_load_dwordx4 v21, s[32:35], s81 offen offset:1024 lds
    ds_read_b128 v[80:83], v220 offset:15648
    ds_read_b128 v[84:87], v220 offset:15664
    ds_read_b128 v[88:91], v220 offset:15552
    ds_read_b128 v[92:95], v220 offset:15568
    ds_read_b128 v[96:99], v220 offset:15456
    ds_read_b128 v[100:103], v220 offset:15472
    buffer_load_dwordx4 v22, s[32:35], s81 offen offset:2048 lds
    v_mov_b32 v168, 0
    v_mov_b32 v169, 0
    v_mov_b32 v170, 0
    v_mov_b32 v171, 0
    v_mov_b32 v172, 0
    v_mov_b32 v173, 0
    buffer_load_dwordx4 v23, s[32:35], s81 offen offset:3072 lds
    v_mov_b32 v174, 0
    v_mov_b32 v175, 0
    v_mov_b32 v176, 0
    v_mov_b32 v177, 0
    v_mov_b32 v178, 0
    v_mov_b32 v179, 0
    s_waitcnt vmcnt(18)
    v_mov_b32 v180, 0
    v_mov_b32 v181, 0
    v_mov_b32 v182, 0
    v_mov_b32 v183, 0
    v_mov_b32 v184, 0
    v_mov_b32 v185, 0
    ds_read_b64_tr_b16 a[76:77], v25 offset:0
    v_mov_b32 v186, 0
    v_mov_b32 v187, 0
    v_mov_b32 v188, 0
    v_mov_b32 v189, 0
    v_mov_b32 v190, 0
    v_mov_b32 v191, 0
    ds_read_b64_tr_b16 a[78:79], v25 offset:1536
    s_lshl_b32 s84, s66, 11
    s_lshl_b32 s85, s64, 9
    s_add_u32 s84, s84, s85
    s_add_u32 s84, s84, s67
    v_lshlrev_b32 v222, 14, v3
    v_lshl_add_u32 v222, v2, 4, v222
    ds_read_b64_tr_b16 a[80:81], v25 offset:8
    v_add_u32 v222, s84, v222
    s_waitcnt lgkmcnt(15)
    v_dot2c_f32_bf16 v168, v32, v40
    v_dot2c_f32_bf16 v168, v33, v41
    v_dot2c_f32_bf16 v168, v34, v42
    v_dot2c_f32_bf16 v168, v35, v43
    v_dot2c_f32_bf16 v168, v36, v44
    ds_read_b64_tr_b16 a[82:83], v25 offset:1544
    v_dot2c_f32_bf16 v168, v37, v45
    v_dot2c_f32_bf16 v168, v38, v46
    v_dot2c_f32_bf16 v168, v39, v47
    ds_read_b128 v[104:107], v220 offset:31488
    ds_read_b128 v[108:111], v220 offset:31504
    v_dot2c_f32_bf16 v169, v32, v48
    ds_read_b64_tr_b16 a[84:85], v25 offset:16
    v_dot2c_f32_bf16 v169, v33, v49
    v_dot2c_f32_bf16 v169, v34, v50
    v_dot2c_f32_bf16 v169, v35, v51
    v_dot2c_f32_bf16 v169, v36, v52
    v_dot2c_f32_bf16 v169, v37, v53
    v_dot2c_f32_bf16 v169, v38, v54
    ds_read_b64_tr_b16 a[86:87], v25 offset:1552
    v_dot2c_f32_bf16 v169, v39, v55
    ds_read_b128 v[112:115], v220 offset:31392
    ds_read_b128 v[116:119], v220 offset:31408
    s_waitcnt lgkmcnt(15)
    v_dot2c_f32_bf16 v170, v32, v56
    v_dot2c_f32_bf16 v170, v33, v57
    v_dot2c_f32_bf16 v170, v34, v58
    s_waitcnt vmcnt(15)
    v_dot2c_f32_bf16 v170, v35, v59
    v_dot2c_f32_bf16 v170, v36, v60
    v_dot2c_f32_bf16 v170, v37, v61
    v_dot2c_f32_bf16 v170, v38, v62
    v_dot2c_f32_bf16 v170, v39, v63
    ds_read_b128 v[120:123], v220 offset:31296
    ds_read_b64_tr_b16 a[88:89], v25 offset:3072
    ds_read_b128 v[124:127], v220 offset:31312
    v_dot2c_f32_bf16 v171, v32, v64
    v_dot2c_f32_bf16 v171, v33, v65
    v_dot2c_f32_bf16 v171, v34, v66
    v_dot2c_f32_bf16 v171, v35, v67
    v_dot2c_f32_bf16 v171, v36, v68
    ds_read_b64_tr_b16 a[90:91], v25 offset:4608
    v_dot2c_f32_bf16 v171, v37, v69
    v_dot2c_f32_bf16 v171, v38, v70
    v_dot2c_f32_bf16 v171, v39, v71
    ds_read_b128 v[128:131], v220 offset:31200
    ds_read_b128 v[132:135], v220 offset:31216
    v_dot2c_f32_bf16 v172, v32, v72
    ds_read_b64_tr_b16 a[92:93], v25 offset:3080
    v_dot2c_f32_bf16 v172, v33, v73
    v_dot2c_f32_bf16 v172, v34, v74
    v_dot2c_f32_bf16 v172, v35, v75
    v_dot2c_f32_bf16 v172, v36, v76
    v_dot2c_f32_bf16 v172, v37, v77
    v_dot2c_f32_bf16 v172, v38, v78
    ds_read_b64_tr_b16 a[94:95], v25 offset:4616
    v_dot2c_f32_bf16 v172, v39, v79
    ds_read_b128 v[136:139], v220 offset:31104
    ds_read_b128 v[140:143], v220 offset:31120
    v_dot2c_f32_bf16 v173, v32, v80
    v_dot2c_f32_bf16 v173, v33, v81
    v_dot2c_f32_bf16 v173, v34, v82
    ds_read_b64_tr_b16 a[96:97], v25 offset:3088
    v_dot2c_f32_bf16 v173, v35, v83
    s_waitcnt lgkmcnt(15)
    v_dot2c_f32_bf16 v173, v36, v84
    v_dot2c_f32_bf16 v173, v37, v85
    v_dot2c_f32_bf16 v173, v38, v86
    v_dot2c_f32_bf16 v173, v39, v87
    ds_read_b128 v[144:147], v220 offset:31008
    ds_read_b64_tr_b16 a[98:99], v25 offset:4624
    ds_read_b128 v[148:151], v220 offset:31024
    v_dot2c_f32_bf16 v174, v32, v88
    v_dot2c_f32_bf16 v174, v33, v89
    v_dot2c_f32_bf16 v174, v34, v90
    v_dot2c_f32_bf16 v174, v35, v91
    v_dot2c_f32_bf16 v174, v36, v92
    s_waitcnt lgkmcnt(1)
    s_add_u32 m0, s80, 0
    s_add_u32 s81, s3, 3
    s_and_b32 s81, s81, 3
    s_lshl_b32 s81, s81, 15
    s_add_u32 s81, s81, s89
    v_dot2c_f32_bf16 v174, v37, v93
    v_dot2c_f32_bf16 v174, v38, v94
    v_dot2c_f32_bf16 v174, v39, v95
    ds_read_b128 v[152:155], v220 offset:30912
    ds_read_b128 v[156:159], v220 offset:30928
    v_dot2c_f32_bf16 v175, v32, v96
    buffer_load_dwordx4 v20, s[32:35], s81 offen offset:0 lds
    v_dot2c_f32_bf16 v175, v33, v97
    v_dot2c_f32_bf16 v175, v34, v98
    v_dot2c_f32_bf16 v175, v35, v99
    v_dot2c_f32_bf16 v175, v36, v100
    v_dot2c_f32_bf16 v175, v37, v101
    v_dot2c_f32_bf16 v175, v38, v102
    buffer_load_dwordx4 v21, s[32:35], s81 offen offset:1024 lds
    v_dot2c_f32_bf16 v175, v39, v103
    ds_read_b128 v[160:163], v220 offset:30816
    ds_read_b128 v[164:167], v220 offset:30832
    s_cmp_lg_u32 s65, 0
    s_nop 3
    s_cbranch_scc1 NOMASK
    v_mov_b32 v192, 0xff800000
    v_cmp_gt_u32 vcc, 2, v221
    s_nop 1
    v_cndmask_b32 v169, v169, v192, vcc
    v_cmp_gt_u32 vcc, 4, v221
    s_nop 1
    v_cndmask_b32 v170, v170, v192, vcc
    v_cmp_gt_u32 vcc, 6, v221
    s_nop 1
    v_cndmask_b32 v171, v171, v192, vcc
    v_cmp_gt_u32 vcc, 8, v221
    s_nop 1
    v_cndmask_b32 v172, v172, v192, vcc
    v_cmp_gt_u32 vcc, 10, v221
    s_nop 1
    v_cndmask_b32 v173, v173, v192, vcc
    v_cmp_gt_u32 vcc, 12, v221
    s_nop 1
    v_cndmask_b32 v174, v174, v192, vcc
    v_cmp_gt_u32 vcc, 14, v221
    s_nop 1
    v_cndmask_b32 v175, v175, v192, vcc
    s_nop 7
NOMASK:
    v_max3_f32 v192, v168, v169, v170
    v_max3_f32 v193, v171, v172, v173
    v_max3_f32 v192, v192, v174, v175
    v_max_f32 v192, v192, v193
    s_mov_b32 s84, 0x3eb8aa3b
    v_mul_f32 v192, s84, v192
    buffer_load_dwordx4 v22, s[32:35], s81 offen offset:2048 lds
    v_fma_f32 v168, v168, s84, -v192
    v_fma_f32 v169, v169, s84, -v192
    v_fma_f32 v170, v170, s84, -v192
    v_fma_f32 v171, v171, s84, -v192
    v_fma_f32 v172, v172, s84, -v192
    v_fma_f32 v173, v173, s84, -v192
    buffer_load_dwordx4 v23, s[32:35], s81 offen offset:3072 lds
    v_fma_f32 v174, v174, s84, -v192
    v_fma_f32 v175, v175, s84, -v192
    v_exp_f32 v168, v168
    v_exp_f32 v169, v169
    v_exp_f32 v170, v170
    v_exp_f32 v171, v171
    s_waitcnt vmcnt(16)
    v_exp_f32 v172, v172
    v_exp_f32 v173, v173
    v_exp_f32 v174, v174
    v_exp_f32 v175, v175
    v_pk_add_f32 v[192:193], v[168:169], v[170:171]
    v_pk_add_f32 v[194:195], v[172:173], v[174:175]
    ds_read_b64_tr_b16 a[100:101], v25 offset:6144
    v_pk_add_f32 v[192:193], v[192:193], v[194:195]
    v_add_f32 v192, v192, v193
    v_rcp_f32 v192, v192
    s_nop 0
    v_pk_mul_f32 v[168:169], v[168:169], v[192:193] op_sel:[0,0] op_sel_hi:[1,0]
    v_pk_mul_f32 v[170:171], v[170:171], v[192:193] op_sel:[0,0] op_sel_hi:[1,0]
    v_pk_mul_f32 v[172:173], v[172:173], v[192:193] op_sel:[0,0] op_sel_hi:[1,0]
    ds_read_b64_tr_b16 a[102:103], v25 offset:7680
    v_pk_mul_f32 v[174:175], v[174:175], v[192:193] op_sel:[0,0] op_sel_hi:[1,0]
    v_cvt_pk_bf16_f32 v208, v168, v169
    v_cvt_pk_bf16_f32 v209, v170, v171
    v_cvt_pk_bf16_f32 v210, v172, v173
    v_cvt_pk_bf16_f32 v211, v174, v175
    v_perm_b32 v192, v112, v104, s87
    ds_read_b64_tr_b16 a[104:105], v25 offset:6152
    v_perm_b32 v193, v112, v104, s88
    v_perm_b32 v194, v113, v105, s87
    v_perm_b32 v195, v113, v105, s88
    v_perm_b32 v196, v114, v106, s87
    v_perm_b32 v197, v114, v106, s88
    v_perm_b32 v198, v115, v107, s87
    ds_read_b64_tr_b16 a[106:107], v25 offset:7688
    v_perm_b32 v199, v115, v107, s88
    v_dot2c_f32_bf16 v176, v208, v192
    v_dot2c_f32_bf16 v177, v208, v193
    v_dot2c_f32_bf16 v178, v208, v194
    v_dot2c_f32_bf16 v179, v208, v195
    v_dot2c_f32_bf16 v180, v208, v196
    ds_read_b64_tr_b16 a[108:109], v25 offset:6160
    v_dot2c_f32_bf16 v181, v208, v197
    v_dot2c_f32_bf16 v182, v208, v198
    v_dot2c_f32_bf16 v183, v208, v199
    v_perm_b32 v192, v116, v108, s87
    v_perm_b32 v193, v116, v108, s88
    v_perm_b32 v194, v117, v109, s87
    ds_read_b64_tr_b16 a[110:111], v25 offset:7696
    v_perm_b32 v195, v117, v109, s88
    v_perm_b32 v196, v118, v110, s87
    v_perm_b32 v197, v118, v110, s88
    v_perm_b32 v198, v119, v111, s87
    v_perm_b32 v199, v119, v111, s88
    v_dot2c_f32_bf16 v184, v208, v192
    s_waitcnt lgkmcnt(0)
    s_add_u32 m0, s80, 4096
    s_add_u32 s81, s3, 1
    s_and_b32 s81, s81, 3
    s_mul_i32 s81, s81, 88064
    v_dot2c_f32_bf16 v185, v208, v193
    v_dot2c_f32_bf16 v186, v208, v194
    v_dot2c_f32_bf16 v187, v208, v195
    v_dot2c_f32_bf16 v188, v208, v196
    v_dot2c_f32_bf16 v189, v208, v197
    v_dot2c_f32_bf16 v190, v208, v198
    buffer_load_dwordx4 v17, s[36:39], s81 offen offset:0 lds
    v_dot2c_f32_bf16 v191, v208, v199
    v_perm_b32 v192, v128, v120, s87
    v_perm_b32 v193, v128, v120, s88
    v_perm_b32 v194, v129, v121, s87
    v_perm_b32 v195, v129, v121, s88
    v_perm_b32 v196, v130, v122, s87
    buffer_load_dwordx4 v18, s[36:39], s81 offen offset:1024 lds
    v_perm_b32 v197, v130, v122, s88
    v_perm_b32 v198, v131, v123, s87
    v_perm_b32 v199, v131, v123, s88
    v_dot2c_f32_bf16 v176, v209, v192
    v_dot2c_f32_bf16 v177, v209, v193
    v_dot2c_f32_bf16 v178, v209, v194
    buffer_load_dwordx4 v19, s[36:39], s81 offen offset:2048 lds
    v_dot2c_f32_bf16 v179, v209, v195
    v_dot2c_f32_bf16 v180, v209, v196
    v_dot2c_f32_bf16 v181, v209, v197
    v_dot2c_f32_bf16 v182, v209, v198
    v_dot2c_f32_bf16 v183, v209, v199
    v_perm_b32 v192, v132, v124, s87
    s_waitcnt vmcnt(12)
    v_perm_b32 v193, v132, v124, s88
    v_perm_b32 v194, v133, v125, s87
    v_perm_b32 v195, v133, v125, s88
    v_perm_b32 v196, v134, v126, s87
    v_perm_b32 v197, v134, v126, s88
    v_perm_b32 v198, v135, v127, s87
    ds_read_b64_tr_b16 a[16:17], v26 offset:9216
    v_perm_b32 v199, v135, v127, s88
    v_dot2c_f32_bf16 v184, v209, v192
    v_dot2c_f32_bf16 v185, v209, v193
    v_dot2c_f32_bf16 v186, v209, v194
    v_dot2c_f32_bf16 v187, v209, v195
    v_dot2c_f32_bf16 v188, v209, v196
    ds_read_b64_tr_b16 a[18:19], v26 offset:11264
    v_dot2c_f32_bf16 v189, v209, v197
    v_dot2c_f32_bf16 v190, v209, v198
    v_dot2c_f32_bf16 v191, v209, v199
    v_perm_b32 v192, v144, v136, s87
    v_perm_b32 v193, v144, v136, s88
    v_perm_b32 v194, v145, v137, s87
    ds_read_b64_tr_b16 a[20:21], v26 offset:9224
    v_perm_b32 v195, v145, v137, s88
    v_perm_b32 v196, v146, v138, s87
    v_perm_b32 v197, v146, v138, s88
    v_perm_b32 v198, v147, v139, s87
    v_perm_b32 v199, v147, v139, s88
    v_dot2c_f32_bf16 v176, v210, v192
    ds_read_b64_tr_b16 a[22:23], v26 offset:11272
    v_dot2c_f32_bf16 v177, v210, v193
    v_dot2c_f32_bf16 v178, v210, v194
    v_dot2c_f32_bf16 v179, v210, v195
    v_dot2c_f32_bf16 v180, v210, v196
    v_dot2c_f32_bf16 v181, v210, v197
    v_dot2c_f32_bf16 v182, v210, v198
    ds_read_b64_tr_b16 a[24:25], v27 offset:9216
    v_dot2c_f32_bf16 v183, v210, v199
    v_perm_b32 v192, v148, v140, s87
    v_perm_b32 v193, v148, v140, s88
    v_perm_b32 v194, v149, v141, s87
    v_perm_b32 v195, v149, v141, s88
    v_perm_b32 v196, v150, v142, s87
    ds_read_b64_tr_b16 a[26:27], v27 offset:11264
    v_perm_b32 v197, v150, v142, s88
    v_perm_b32 v198, v151, v143, s87
    v_perm_b32 v199, v151, v143, s88
    v_dot2c_f32_bf16 v184, v210, v192
    v_dot2c_f32_bf16 v185, v210, v193
    v_dot2c_f32_bf16 v186, v210, v194
    ds_read_b64_tr_b16 a[28:29], v27 offset:9224
    v_dot2c_f32_bf16 v187, v210, v195
    v_dot2c_f32_bf16 v188, v210, v196
    v_dot2c_f32_bf16 v189, v210, v197
    v_dot2c_f32_bf16 v190, v210, v198
    v_dot2c_f32_bf16 v191, v210, v199
    v_perm_b32 v192, v160, v152, s87
    ds_read_b64_tr_b16 a[30:31], v27 offset:11272
    v_perm_b32 v193, v160, v152, s88
    v_perm_b32 v194, v161, v153, s87
    v_perm_b32 v195, v161, v153, s88
    v_perm_b32 v196, v162, v154, s87
    v_perm_b32 v197, v162, v154, s88
    v_perm_b32 v198, v163, v155, s87
    s_waitcnt lgkmcnt(0)
    s_add_u32 m0, s80, 7168
    s_add_u32 s81, s3, 1
    s_and_b32 s81, s81, 3
    s_mul_i32 s81, s81, 88064
    s_add_u32 s81, s81, 352256
    v_perm_b32 v199, v163, v155, s88
    v_dot2c_f32_bf16 v176, v211, v192
    v_dot2c_f32_bf16 v177, v211, v193
    v_dot2c_f32_bf16 v178, v211, v194
    v_dot2c_f32_bf16 v179, v211, v195
    v_dot2c_f32_bf16 v180, v211, v196
    buffer_load_dwordx4 v17, s[36:39], s81 offen offset:0 lds
    v_dot2c_f32_bf16 v181, v211, v197
    v_dot2c_f32_bf16 v182, v211, v198
    v_dot2c_f32_bf16 v183, v211, v199
    v_perm_b32 v192, v164, v156, s87
    v_perm_b32 v193, v164, v156, s88
    v_perm_b32 v194, v165, v157, s87
    buffer_load_dwordx4 v18, s[36:39], s81 offen offset:1024 lds
    v_perm_b32 v195, v165, v157, s88
    v_perm_b32 v196, v166, v158, s87
    v_perm_b32 v197, v166, v158, s88
    v_perm_b32 v198, v167, v159, s87
    v_perm_b32 v199, v167, v159, s88
    v_dot2c_f32_bf16 v184, v211, v192
    buffer_load_dwordx4 v19, s[36:39], s81 offen offset:2048 lds
    v_dot2c_f32_bf16 v185, v211, v193
    v_dot2c_f32_bf16 v186, v211, v194
    v_dot2c_f32_bf16 v187, v211, v195
    v_dot2c_f32_bf16 v188, v211, v196
    v_dot2c_f32_bf16 v189, v211, v197
    v_dot2c_f32_bf16 v190, v211, v198
    s_add_u32 m0, s80, 10240
    s_add_u32 s81, s3, 1
    s_and_b32 s81, s81, 3
    s_mul_i32 s81, s81, 88064
    s_add_u32 s81, s81, 704512
    v_dot2c_f32_bf16 v191, v211, v199
    v_cvt_pk_bf16_f32 v212, v176, v177
    v_cvt_pk_bf16_f32 v213, v178, v179
    v_cvt_pk_bf16_f32 v214, v180, v181
    v_cvt_pk_bf16_f32 v215, v182, v183
    v_cvt_pk_bf16_f32 v216, v184, v185
    buffer_load_dwordx4 v17, s[36:39], s81 offen offset:0 lds
    v_cvt_pk_bf16_f32 v217, v186, v187
    v_cvt_pk_bf16_f32 v218, v188, v189
    v_cvt_pk_bf16_f32 v219, v190, v191
    buffer_load_dwordx4 v18, s[36:39], s81 offen offset:1024 lds
    buffer_load_dwordx4 v19, s[36:39], s81 offen offset:2048 lds
    s_waitcnt vmcnt(17)
    v_cmp_ne_u32 vcc, v224, v28
    s_nop 4
    s_cmp_eq_u64 vcc, 0
    s_cselect_b32 s2, 1, 0
    s_cmp_eq_u32 s2, 1
    s_cbranch_scc1 DF_0
    buffer_store_dwordx4 v[212:215], v222, s[52:55], 0 offen sc1
    buffer_store_dwordx4 v[216:219], v222, s[52:55], 0 offen offset:256 sc1
    s_branch DE_0
DF_0:
    buffer_store_dwordx4 v[212:215], v222, s[52:55], 0 offen sc1
    buffer_store_dwordx4 v[216:219], v222, s[52:55], 0 offen offset:256 sc1
DE_0:
    s_mul_i32 s84, s64, 11264
    v_add_u32 v14, s84, v1
    s_mul_i32 s85, s3, 3072
    s_add_u32 s76, s76, s85
    s_add_u32 s77, s77, s85
    s_add_u32 s78, s78, s85
    s_add_u32 s79, s79, s85
    s_add_u32 s84, s3, 0
    s_and_b32 s84, s84, 3
    s_lshl_b32 s84, s84, 10
    v_add_u32 v6, s84, v1
    s_add_u32 s84, s3, 1
    s_and_b32 s84, s84, 3
    s_lshl_b32 s84, s84, 10
    v_add_u32 v7, s84, v1
    s_add_u32 s84, s3, 2
    s_and_b32 s84, s84, 3
    s_lshl_b32 s84, s84, 10
    v_add_u32 v8, s84, v1
    s_add_u32 s84, s3, 3
    s_and_b32 s84, s84, 3
    s_lshl_b32 s84, s84, 10
    v_add_u32 v9, s84, v1
    v_and_b32 v32, 1, v3
    v_mul_u32_u24 v32, 49152, v32
    v_lshrrev_b32 v33, 1, v3
    v_mul_u32_u24 v33, 768, v33
    v_add_u32 v32, v32, v33
    v_lshl_add_u32 v32, v2, 4, v32
    s_mul_i32 s84, s67, 3
    s_lshl_b32 s85, s91, 4
    s_add_u32 s84, s84, s85
    v_add_u32 v15, s84, v32
    s_add_u32 s68, s72, 0
    s_add_u32 s69, s72, 4096
    s_add_u32 s70, s72, 8192
    s_add_u32 s71, s72, 12288
    v_lshrrev_b32 v30, 1, v1
    v_add_u32 v30, 159744, v30
    v_bfe_u32 v32, v1, 4, 5
    v_lshrrev_b32 v33, 9, v1
    v_mul_u32_u24 v33, 360448, v33
    v_lshl_add_u32 v33, v32, 10, v33
    s_waitcnt vmcnt(0)
    s_barrier
    s_mov_b32 s83, 0x40000
INIT_0:
    v_readfirstlane_b32 s84, v11
    s_nop 1
    s_cmp_eq_u32 s84, 1
    s_cbranch_scc1 INITOK_0
    buffer_load_dword v11, off, s[48:51], 0 sc1
    s_waitcnt vmcnt(0)
    s_sub_u32 s83, s83, 1
    s_cmp_lg_u32 s83, 0
    s_cbranch_scc1 INIT_0
INITOK_0:
    s_cmp_lg_u32 s64, 0
    s_cbranch_scc1 PF_0
    v_mov_b32 v12, 1
    s_mov_b64 exec, 1
    s_cmp_eq_u32 s2, 1
    s_cbranch_scc1 FF_0
    buffer_store_dword v28, off, s[60:63], s92 offset:4 sc1
    buffer_store_dword v12, off, s[60:63], s92 sc1
    s_branch FE_0
FF_0:
    buffer_store_dword v12, off, s[60:63], s92
FE_0:
    s_mov_b64 exec, -1
    s_branch NOPOST_0
PF_0:
    s_mov_b32 m0, 160384
    s_and_b32 s84, s64, 1
    s_xor_b32 s84, s84, 1
    s_lshl_b32 s85, s66, 1
    s_add_u32 s84, s84, s85
    s_lshl_b32 s84, s84, 10
    s_add_u32 s84, s84, s67
    buffer_load_dwordx4 v1, s[52:55], s84 offen sc1 lds
    s_add_u32 s84, s84, 16384
    buffer_load_dwordx4 v1, s[52:55], s84 offen sc1 lds
    s_add_u32 s84, s84, 16384
    buffer_load_dwordx4 v1, s[52:55], s84 offen sc1 lds
    s_add_u32 s84, s84, 16384
    buffer_load_dwordx4 v1, s[52:55], s84 offen sc1 lds
NOPOST_0:
    ds_read_b64_tr_b16 a[32:33], v26 offset:13312
    ds_read_b64_tr_b16 a[34:35], v26 offset:15360
    ds_read_b64_tr_b16 a[36:37], v26 offset:13320
    ds_read_b64_tr_b16 a[38:39], v26 offset:15368
    ds_read_b64_tr_b16 a[40:41], v27 offset:13312
    ds_read_b64_tr_b16 a[42:43], v27 offset:15360
    ds_read_b64_tr_b16 a[44:45], v27 offset:13320
    ds_read_b64_tr_b16 a[46:47], v27 offset:15368
    ds_read_b64_tr_b16 a[48:49], v26 offset:0
    ds_read_b64_tr_b16 a[50:51], v26 offset:2048
    ds_read_b64_tr_b16 a[52:53], v26 offset:8
    ds_read_b64_tr_b16 a[54:55], v26 offset:2056
    ds_read_b64_tr_b16 a[56:57], v27 offset:0
    ds_read_b64_tr_b16 a[58:59], v27 offset:2048
    ds_read_b64_tr_b16 a[60:61], v27 offset:8
    ds_read_b64_tr_b16 a[62:63], v27 offset:2056
    s_waitcnt lgkmcnt(8)
    s_add_u32 m0, s80, 13312
    s_add_u32 s81, s3, 1
    s_and_b32 s81, s81, 3
    s_mul_i32 s81, s81, 88064
    s_add_u32 s81, s81, 1056768
    buffer_load_dwordx4 v17, s[36:39], s81 offen offset:0 lds
    buffer_load_dwordx4 v18, s[36:39], s81 offen offset:1024 lds
    buffer_load_dwordx4 v19, s[36:39], s81 offen offset:2048 lds
    s_add_u32 m0, s80, 16384
    s_add_u32 s81, s3, 2
    s_and_b32 s81, s81, 3
    s_mul_i32 s81, s81, 88064
    buffer_load_dwordx4 v17, s[36:39], s81 offen offset:0 lds
    buffer_load_dwordx4 v18, s[36:39], s81 offen offset:1024 lds
    buffer_load_dwordx4 v19, s[36:39], s81 offen offset:2048 lds
    s_waitcnt lgkmcnt(0)
    s_add_u32 m0, s80, 0
    s_add_u32 s81, s3, 2
    s_and_b32 s81, s81, 3
    s_mul_i32 s81, s81, 88064
    s_add_u32 s81, s81, 352256
    buffer_load_dwordx4 v17, s[36:39], s81 offen offset:0 lds
    buffer_load_dwordx4 v18, s[36:39], s81 offen offset:1024 lds
    buffer_load_dwordx4 v19, s[36:39], s81 offen offset:2048 lds
    s_mov_b32 s83, 0x40000
POLL_0:
    buffer_load_dwordx2 v[10:11], v13, s[60:63], s82 offen sc1
    s_waitcnt vmcnt(0)
    v_cmp_gt_u32 vcc, 1, v10
    s_nop 4
    s_cbranch_vccz DONE_0
    s_sub_u32 s83, s83, 1
    s_cmp_lg_u32 s83, 0
    s_cbranch_scc1 POLL_0
DONE_0:
    v_cmp_ne_u32 vcc, v11, v28
    s_nop 4
    s_cmp_eq_u64 vcc, 0
    s_cselect_b32 s2, 1, 0
TAIL:
    s_lshl_b32 s85, s64, 12
    s_add_u32 s85, s85, s73
    buffer_load_dwordx4 v[140:143], v6, s[52:55], s85 offen sc1
    buffer_load_dwordx4 v[144:147], v7, s[52:55], s85 offen sc1
    buffer_load_dwordx4 v[148:151], v8, s[52:55], s85 offen sc1
    buffer_load_dwordx4 v[152:155], v9, s[52:55], s85 offen sc1
    s_lshl_b32 s85, s64, 12
    s_add_u32 s85, s85, s74
    buffer_load_dwordx4 v[156:159], v6, s[52:55], s85 offen sc1
    buffer_load_dwordx4 v[160:163], v7, s[52:55], s85 offen sc1
    buffer_load_dwordx4 v[164:167], v8, s[52:55], s85 offen sc1
    buffer_load_dwordx4 v[168:171], v9, s[52:55], s85 offen sc1
    s_lshl_b32 s85, s64, 12
    s_add_u32 s85, s85, s75
    buffer_load_dwordx4 v[172:175], v6, s[52:55], s85 offen sc1
    buffer_load_dwordx4 v[176:179], v7, s[52:55], s85 offen sc1
    buffer_load_dwordx4 v[180:183], v8, s[52:55], s85 offen sc1
    buffer_load_dwordx4 v[184:187], v9, s[52:55], s85 offen sc1
    s_lshl_b32 s85, s64, 12
    s_add_u32 s85, s85, s72
    buffer_load_dwordx4 v[124:127], v6, s[52:55], s85 offen sc1
    buffer_load_dwordx4 v[128:131], v7, s[52:55], s85 offen sc1
    buffer_load_dwordx4 v[132:135], v8, s[52:55], s85 offen sc1
    buffer_load_dwordx4 v[136:139], v9, s[52:55], s85 offen sc1
    s_cmp_ge_u32 s3, 4
    s_cselect_b32 s81, 360448, 0
    s_sub_u32 s81, s90, s81
    s_lshl_b32 m0, s66, 7
    s_add_u32 s81, s81, m0
    s_mov_b32 m0, 160384
    s_mov_b64 exec, 0xffffffff
    buffer_load_dword v5, s[40:43], s81 offen lds
    s_mov_b64 exec, -1
    s_cmp_ge_u32 s3, 4
    s_cselect_b32 s81, 360448, 0
    s_sub_u32 s81, s90, s81
    s_add_u32 s81, s81, 32768
    s_lshl_b32 m0, s66, 7
    s_add_u32 s81, s81, m0
    s_mov_b32 m0, 160384
    s_mov_b64 exec, 0xffffffff
    buffer_load_dword v5, s[40:43], s81 offen lds
    s_mov_b64 exec, -1
    s_cmp_ge_u32 s3, 3
    s_cselect_b32 s81, 360448, 0
    s_sub_u32 s81, s90, s81
    s_add_u32 s81, s81, 65536
    s_lshl_b32 m0, s66, 7
    s_add_u32 s81, s81, m0
    s_mov_b32 m0, 160384
    s_mov_b64 exec, 0xffffffff
    buffer_load_dword v5, s[40:43], s81 offen lds
    s_mov_b64 exec, -1
    v_mov_b32 v246, 0
    v_mov_b32 v247, 0
    v_mov_b32 v248, 0
    v_mov_b32 v249, 0
    s_add_u32 s84, s64, 1
    s_and_b32 s84, s84, 3
    ds_read_b64_tr_b16 a[112:113], v25 offset:4096
    s_mul_i32 s84, s84, 12288
    v_add_u32 v96, s84, v1
    s_add_u32 s84, s64, 2
    ds_read_b64_tr_b16 a[114:115], v25 offset:5632
    s_and_b32 s84, s84, 3
    s_mul_i32 s84, s84, 12288
    v_add_u32 v97, s84, v1
    ds_read_b64_tr_b16 a[116:117], v25 offset:4104
    s_add_u32 s84, s64, 3
    s_and_b32 s84, s84, 3
    s_mul_i32 s84, s84, 12288
    ds_read_b64_tr_b16 a[118:119], v25 offset:5640
    v_add_u32 v98, s84, v1
    s_mul_i32 s84, s64, 12288
    v_add_u32 v99, s84, v1
    ds_read_b64_tr_b16 a[120:121], v25 offset:4112
    v_lshlrev_b32 v32, 16, v238
    v_and_b32 v33, 0xffff0000, v238
    v_lshlrev_b32 v34, 16, v239
    ds_read_b64_tr_b16 a[122:123], v25 offset:5648
    v_and_b32 v35, 0xffff0000, v239
    v_lshlrev_b32 v36, 16, v240
    v_and_b32 v37, 0xffff0000, v240
    s_waitcnt lgkmcnt(0)
    s_add_u32 m0, s80, 3072
    s_add_u32 s81, s3, 2
    s_and_b32 s81, s81, 3
    s_mul_i32 s81, s81, 88064
    s_add_u32 s81, s81, 704512
    v_lshlrev_b32 v38, 16, v241
    v_and_b32 v39, 0xffff0000, v241
    v_lshlrev_b32 v40, 16, v242
    buffer_load_dwordx4 v17, s[36:39], s81 offen offset:0 lds
    v_and_b32 v41, 0xffff0000, v242
    v_lshlrev_b32 v42, 16, v243
    v_and_b32 v43, 0xffff0000, v243
    buffer_load_dwordx4 v18, s[36:39], s81 offen offset:1024 lds
    v_lshlrev_b32 v44, 16, v244
    v_and_b32 v45, 0xffff0000, v244
    v_lshlrev_b32 v46, 16, v245
    buffer_load_dwordx4 v19, s[36:39], s81 offen offset:2048 lds
    v_and_b32 v47, 0xffff0000, v245
    s_waitcnt vmcnt(21)
    v_mfma_f32_16x16x32_bf16 v[48:51], a[0:3], v[140:143], 0
    v_mfma_f32_16x16x32_bf16 v[52:55], a[4:7], v[140:143], 0
    v_mfma_f32_16x16x32_bf16 v[56:59], a[8:11], v[140:143], 0
    v_mfma_f32_16x16x32_bf16 v[60:63], a[12:15], v[140:143], 0
    s_waitcnt vmcnt(20)
    v_mfma_f32_16x16x32_bf16 v[48:51], a[16:19], v[144:147], v[48:51]
    ds_read_b64_tr_b16 a[124:125], v25 offset:7168
    v_mfma_f32_16x16x32_bf16 v[52:55], a[20:23], v[144:147], v[52:55]
    v_mfma_f32_16x16x32_bf16 v[56:59], a[24:27], v[144:147], v[56:59]
    v_mfma_f32_16x16x32_bf16 v[60:63], a[28:31], v[144:147], v[60:63]
    ds_read_b64_tr_b16 a[126:127], v25 offset:8704
    s_waitcnt vmcnt(19)
    v_mfma_f32_16x16x32_bf16 v[48:51], a[32:35], v[148:151], v[48:51]
    v_mfma_f32_16x16x32_bf16 v[52:55], a[36:39], v[148:151], v[52:55]
    v_mfma_f32_16x16x32_bf16 v[56:59], a[40:43], v[148:151], v[56:59]
    ds_read_b64_tr_b16 a[128:129], v25 offset:7176
    v_mfma_f32_16x16x32_bf16 v[60:63], a[44:47], v[148:151], v[60:63]
    s_waitcnt vmcnt(18)
    v_mfma_f32_16x16x32_bf16 v[48:51], a[48:51], v[152:155], v[48:51]
    v_mfma_f32_16x16x32_bf16 v[52:55], a[52:55], v[152:155], v[52:55]
    ds_read_b64_tr_b16 a[130:131], v25 offset:8712
    v_mfma_f32_16x16x32_bf16 v[56:59], a[56:59], v[152:155], v[56:59]
    v_mfma_f32_16x16x32_bf16 v[60:63], a[60:63], v[152:155], v[60:63]
    s_waitcnt vmcnt(17)
    v_mfma_f32_16x16x32_bf16 v[64:67], a[0:3], v[156:159], 0
    ds_read_b64_tr_b16 a[132:133], v25 offset:7184
    v_mfma_f32_16x16x32_bf16 v[68:71], a[4:7], v[156:159], 0
    v_mfma_f32_16x16x32_bf16 v[72:75], a[8:11], v[156:159], 0
    v_mfma_f32_16x16x32_bf16 v[76:79], a[12:15], v[156:159], 0
    ds_read_b64_tr_b16 a[134:135], v25 offset:8720
    s_waitcnt vmcnt(16)
    v_mfma_f32_16x16x32_bf16 v[64:67], a[16:19], v[160:163], v[64:67]
    ds_write_b128 v96, v[48:51] offset:0
    v_mfma_f32_16x16x32_bf16 v[68:71], a[20:23], v[160:163], v[68:71]
    s_waitcnt lgkmcnt(1)
    s_add_u32 m0, s80, 6144
    s_add_u32 s81, s3, 2
    s_and_b32 s81, s81, 3
    s_mul_i32 s81, s81, 88064
    s_add_u32 s81, s81, 1056768
    ds_write_b128 v96, v[52:55] offset:1024
    v_mfma_f32_16x16x32_bf16 v[72:75], a[24:27], v[160:163], v[72:75]
    ds_write_b128 v96, v[56:59] offset:2048
    buffer_load_dwordx4 v17, s[36:39], s81 offen offset:0 lds
    v_mfma_f32_16x16x32_bf16 v[76:79], a[28:31], v[160:163], v[76:79]
    ds_write_b128 v96, v[60:63] offset:3072
    s_waitcnt vmcnt(16)
    v_mfma_f32_16x16x32_bf16 v[64:67], a[32:35], v[164:167], v[64:67]
    buffer_load_dwordx4 v18, s[36:39], s81 offen offset:1024 lds
    v_mfma_f32_16x16x32_bf16 v[68:71], a[36:39], v[164:167], v[68:71]
    v_mfma_f32_16x16x32_bf16 v[72:75], a[40:43], v[164:167], v[72:75]
    v_mfma_f32_16x16x32_bf16 v[76:79], a[44:47], v[164:167], v[76:79]
    buffer_load_dwordx4 v19, s[36:39], s81 offen offset:2048 lds
    s_waitcnt vmcnt(17)
    v_mfma_f32_16x16x32_bf16 v[64:67], a[48:51], v[168:171], v[64:67]
    v_mfma_f32_16x16x32_bf16 v[68:71], a[52:55], v[168:171], v[68:71]
    v_mfma_f32_16x16x32_bf16 v[72:75], a[56:59], v[168:171], v[72:75]
    v_mfma_f32_16x16x32_bf16 v[76:79], a[60:63], v[168:171], v[76:79]
    s_waitcnt vmcnt(16)
    v_mfma_f32_16x16x32_bf16 v[80:83], a[0:3], v[172:175], 0
    v_mfma_f32_16x16x32_bf16 v[84:87], a[4:7], v[172:175], 0
    ds_read_b64_tr_b16 a[136:137], v25 offset:10240
    v_mfma_f32_16x16x32_bf16 v[88:91], a[8:11], v[172:175], 0
    v_mfma_f32_16x16x32_bf16 v[92:95], a[12:15], v[172:175], 0
    s_waitcnt vmcnt(15)
    v_mfma_f32_16x16x32_bf16 v[80:83], a[16:19], v[176:179], v[80:83]
    ds_read_b64_tr_b16 a[138:139], v25 offset:11776
    ds_write_b128 v97, v[64:67] offset:4096
    v_mfma_f32_16x16x32_bf16 v[84:87], a[20:23], v[176:179], v[84:87]
    ds_write_b128 v97, v[68:71] offset:5120
    ds_read_b64_tr_b16 a[140:141], v25 offset:10248
    v_mfma_f32_16x16x32_bf16 v[88:91], a[24:27], v[176:179], v[88:91]
    ds_write_b128 v97, v[72:75] offset:6144
    v_mfma_f32_16x16x32_bf16 v[92:95], a[28:31], v[176:179], v[92:95]
    ds_read_b64_tr_b16 a[142:143], v25 offset:11784
    ds_write_b128 v97, v[76:79] offset:7168
    s_waitcnt vmcnt(14)
    v_mfma_f32_16x16x32_bf16 v[80:83], a[32:35], v[180:183], v[80:83]
    v_mfma_f32_16x16x32_bf16 v[84:87], a[36:39], v[180:183], v[84:87]
    ds_read_b64_tr_b16 a[144:145], v25 offset:10256
    v_mfma_f32_16x16x32_bf16 v[88:91], a[40:43], v[180:183], v[88:91]
    v_mfma_f32_16x16x32_bf16 v[92:95], a[44:47], v[180:183], v[92:95]
    s_waitcnt vmcnt(13)
    v_mfma_f32_16x16x32_bf16 v[80:83], a[48:51], v[184:187], v[80:83]
    ds_read_b64_tr_b16 a[146:147], v25 offset:11792
    v_mfma_f32_16x16x32_bf16 v[84:87], a[52:55], v[184:187], v[84:87]
    v_mfma_f32_16x16x32_bf16 v[88:91], a[56:59], v[184:187], v[88:91]
    v_mfma_f32_16x16x32_bf16 v[92:95], a[60:63], v[184:187], v[92:95]
    s_waitcnt lgkmcnt(0)
    s_add_u32 m0, s80, 9216
    s_add_u32 s81, s3, 3
    s_and_b32 s81, s81, 3
    s_mul_i32 s81, s81, 88064
    s_waitcnt vmcnt(12)
    v_mfma_f32_16x16x32_bf16 v[32:35], a[0:3], v[124:127], v[32:35]
    v_mfma_f32_16x16x32_bf16 v[36:39], a[4:7], v[124:127], v[36:39]
    v_mfma_f32_16x16x32_bf16 v[40:43], a[8:11], v[124:127], v[40:43]
    buffer_load_dwordx4 v17, s[36:39], s81 offen offset:0 lds
    v_mfma_f32_16x16x32_bf16 v[44:47], a[12:15], v[124:127], v[44:47]
    s_waitcnt vmcnt(12)
    v_mfma_f32_16x16x32_bf16 v[32:35], a[16:19], v[128:131], v[32:35]
    ds_write_b128 v98, v[80:83] offset:8192
    buffer_load_dwordx4 v18, s[36:39], s81 offen offset:1024 lds
    v_mfma_f32_16x16x32_bf16 v[36:39], a[20:23], v[128:131], v[36:39]
    ds_write_b128 v98, v[84:87] offset:9216
    v_mfma_f32_16x16x32_bf16 v[40:43], a[24:27], v[128:131], v[40:43]
    buffer_load_dwordx4 v19, s[36:39], s81 offen offset:2048 lds
    ds_write_b128 v98, v[88:91] offset:10240
    v_mfma_f32_16x16x32_bf16 v[44:47], a[28:31], v[128:131], v[44:47]
    ds_write_b128 v98, v[92:95] offset:11264
    s_waitcnt vmcnt(13)
    v_mfma_f32_16x16x32_bf16 v[32:35], a[32:35], v[132:135], v[32:35]
    v_mfma_f32_16x16x32_bf16 v[36:39], a[36:39], v[132:135], v[36:39]
    v_mfma_f32_16x16x32_bf16 v[40:43], a[40:43], v[132:135], v[40:43]
    ds_read_b64_tr_b16 a[148:149], v25 offset:13312
    v_mfma_f32_16x16x32_bf16 v[44:47], a[44:47], v[132:135], v[44:47]
    s_waitcnt vmcnt(12)
    v_mfma_f32_16x16x32_bf16 v[32:35], a[48:51], v[136:139], v[32:35]
    v_mfma_f32_16x16x32_bf16 v[36:39], a[52:55], v[136:139], v[36:39]
    ds_read_b64_tr_b16 a[150:151], v25 offset:14848
    v_mfma_f32_16x16x32_bf16 v[40:43], a[56:59], v[136:139], v[40:43]
    v_mfma_f32_16x16x32_bf16 v[44:47], a[60:63], v[136:139], v[44:47]
    s_waitcnt lgkmcnt(0)
    s_barrier
    ds_read_b64_tr_b16 a[152:153], v25 offset:13320
    ds_read_b128 v[188:191], v99 offset:0
    ds_read_b128 v[192:195], v99 offset:1024
    ds_read_b128 v[196:199], v99 offset:2048
    ds_read_b64_tr_b16 a[154:155], v25 offset:14856
    ds_read_b128 v[200:203], v99 offset:3072
    ds_read_b128 v[204:207], v99 offset:4096
    ds_read_b128 v[208:211], v99 offset:5120
    ds_read_b64_tr_b16 a[156:157], v25 offset:13328
    ds_read_b128 v[212:215], v99 offset:6144
    ds_read_b128 v[216:219], v99 offset:7168
    ds_read_b128 v[220:223], v99 offset:8192
    ds_read_b64_tr_b16 a[158:159], v25 offset:14864
    ds_read_b128 v[224:227], v99 offset:9216
    ds_read_b128 v[228:231], v99 offset:10240
    ds_read_b128 v[232:235], v99 offset:11264
    s_waitcnt lgkmcnt(3)
    s_add_u32 m0, s80, 12288
    s_add_u32 s81, s3, 3
    s_and_b32 s81, s81, 3
    s_mul_i32 s81, s81, 88064
    s_add_u32 s81, s81, 352256
    v_pk_add_f32 v[32:33], v[32:33], v[188:189]
    v_pk_add_f32 v[34:35], v[34:35], v[190:191]
    v_pk_add_f32 v[36:37], v[36:37], v[192:193]
    buffer_load_dwordx4 v17, s[36:39], s81 offen offset:0 lds
    v_pk_add_f32 v[38:39], v[38:39], v[194:195]
    v_pk_add_f32 v[40:41], v[40:41], v[196:197]
    v_pk_add_f32 v[42:43], v[42:43], v[198:199]
    buffer_load_dwordx4 v18, s[36:39], s81 offen offset:1024 lds
    v_pk_add_f32 v[44:45], v[44:45], v[200:201]
    v_pk_add_f32 v[46:47], v[46:47], v[202:203]
    v_pk_add_f32 v[32:33], v[32:33], v[204:205]
    buffer_load_dwordx4 v19, s[36:39], s81 offen offset:2048 lds
    v_pk_add_f32 v[34:35], v[34:35], v[206:207]
    v_pk_add_f32 v[36:37], v[36:37], v[208:209]
    v_pk_add_f32 v[38:39], v[38:39], v[210:211]
    v_pk_add_f32 v[40:41], v[40:41], v[212:213]
    v_pk_add_f32 v[42:43], v[42:43], v[214:215]
    v_pk_add_f32 v[44:45], v[44:45], v[216:217]
    ds_read_b64_tr_b16 a[160:161], v25 offset:16384
    v_pk_add_f32 v[46:47], v[46:47], v[218:219]
    v_pk_add_f32 v[32:33], v[32:33], v[220:221]
    v_pk_add_f32 v[34:35], v[34:35], v[222:223]
    ds_read_b64_tr_b16 a[162:163], v25 offset:17920
    s_waitcnt lgkmcnt(4)
    v_pk_add_f32 v[36:37], v[36:37], v[224:225]
    v_pk_add_f32 v[38:39], v[38:39], v[226:227]
    s_waitcnt lgkmcnt(3)
    v_pk_add_f32 v[40:41], v[40:41], v[228:229]
    ds_read_b64_tr_b16 a[164:165], v25 offset:16392
    v_pk_add_f32 v[42:43], v[42:43], v[230:231]
    s_waitcnt lgkmcnt(3)
    v_pk_add_f32 v[44:45], v[44:45], v[232:233]
    v_pk_add_f32 v[46:47], v[46:47], v[234:235]
    ds_read_b64_tr_b16 a[166:167], v25 offset:17928
    v_cvt_pk_bf16_f32 v238, v32, v33
    v_cvt_pk_bf16_f32 v239, v34, v35
    v_cvt_pk_bf16_f32 v240, v36, v37
    ds_read_b64_tr_b16 a[168:169], v25 offset:16400
    v_cvt_pk_bf16_f32 v241, v38, v39
    v_cvt_pk_bf16_f32 v242, v40, v41
    v_cvt_pk_bf16_f32 v243, v42, v43
    ds_read_b64_tr_b16 a[170:171], v25 offset:17936
    v_cvt_pk_bf16_f32 v244, v44, v45
    v_cvt_pk_bf16_f32 v245, v46, v47
    s_lshl_b32 s84, s66, 11
    s_add_u32 s84, s84, s72
    s_cmp_eq_u32 s2, 1
    s_cbranch_scc1 DF_1
    buffer_store_dwordx4 v[238:241], v1, s[56:59], s84 offen sc1
    buffer_store_dwordx4 v[242:245], v1, s[56:59], s84 offen offset:1024 sc1
    s_branch DE_1
DF_1:
    buffer_store_dwordx4 v[238:241], v1, s[56:59], s84 offen sc1
    buffer_store_dwordx4 v[242:245], v1, s[56:59], s84 offen offset:1024 sc1
DE_1:
    v_dot2c_f32_bf16 v246, s86, v238
    v_dot2c_f32_bf16 v247, v238, v238
    v_dot2c_f32_bf16 v248, s86, v239
    v_dot2c_f32_bf16 v249, v239, v239
    v_dot2c_f32_bf16 v246, s86, v240
    v_dot2c_f32_bf16 v247, v240, v240
    v_dot2c_f32_bf16 v248, s86, v241
    v_dot2c_f32_bf16 v249, v241, v241
    v_dot2c_f32_bf16 v246, s86, v242
    v_dot2c_f32_bf16 v247, v242, v242
    v_dot2c_f32_bf16 v248, s86, v243
    v_dot2c_f32_bf16 v249, v243, v243
    v_dot2c_f32_bf16 v246, s86, v244
    v_dot2c_f32_bf16 v247, v244, v244
    v_dot2c_f32_bf16 v248, s86, v245
    v_dot2c_f32_bf16 v249, v245, v245
    s_lshl_b32 s84, s65, 12
    s_lshl_b32 s85, s66, 9
    s_add_u32 s84, s84, s85
    s_lshl_b32 s85, s64, 7
    s_add_u32 s84, s84, s85
    s_add_u32 s84, s84, 6164480
    v_pk_add_f32 v[246:247], v[246:247], v[248:249]
    s_nop 1
    v_permlane32_swap_b32 v246, v247
    v_add_f32 v246, v246, v247
    v_mov_b32 v247, v246
    s_nop 1
    v_permlane16_swap_b32 v246, v247
    v_add_f32 v246, v246, v247
    v_mov_b32 v247, v246
    s_nop 1
    v_permlane32_swap_b32 v246, v247
    s_mov_b64 exec, 0xffff
    s_cmp_eq_u32 s2, 1
    s_cbranch_scc1 DF_2
    buffer_store_dwordx2 v[246:247], v29, s[60:63], s84 offen sc1
    s_branch DE_2
DF_2:
    buffer_store_dwordx2 v[246:247], v29, s[60:63], s84 offen sc1
DE_2:
    s_mov_b64 exec, -1
    s_waitcnt lgkmcnt(0)
    s_add_u32 m0, s80, 15360
    s_add_u32 s81, s3, 3
    s_and_b32 s81, s81, 3
    s_mul_i32 s81, s81, 88064
    s_add_u32 s81, s81, 704512
    buffer_load_dwordx4 v17, s[36:39], s81 offen offset:0 lds
    buffer_load_dwordx4 v18, s[36:39], s81 offen offset:1024 lds
    buffer_load_dwordx4 v19, s[36:39], s81 offen offset:2048 lds
    s_waitcnt vmcnt(3)
    s_barrier
    s_cmp_lg_u32 s64, 0
    s_cbranch_scc1 PF_1
    v_mov_b32 v12, 2
    s_mov_b64 exec, 1
    s_cmp_eq_u32 s2, 1
    s_cbranch_scc1 FF_1
    buffer_store_dword v12, off, s[60:63], s92 sc1
    s_branch FE_1
FF_1:
    buffer_store_dword v12, off, s[60:63], s92
FE_1:
    s_mov_b64 exec, -1
    s_branch NOPOST_1
PF_1:
    s_mov_b32 m0, 160384
    s_and_b32 s84, s64, 1
    s_xor_b32 s84, s84, 1
    s_lshl_b32 s85, s66, 1
    s_add_u32 s84, s84, s85
    s_lshl_b32 s84, s84, 10
    s_add_u32 s84, s84, s67
    buffer_load_dwordx4 v1, s[56:59], s84 offen sc1 lds
    s_add_u32 s84, s84, 16384
    buffer_load_dwordx4 v1, s[56:59], s84 offen sc1 lds
    s_add_u32 s84, s84, 16384
    buffer_load_dwordx4 v1, s[56:59], s84 offen sc1 lds
    s_add_u32 s84, s84, 16384
    buffer_load_dwordx4 v1, s[56:59], s84 offen sc1 lds
NOPOST_1:
    ds_read_b64_tr_b16 a[172:173], v25 offset:0
    ds_read_b64_tr_b16 a[174:175], v25 offset:1536
    ds_read_b64_tr_b16 a[176:177], v25 offset:8
    ds_read_b64_tr_b16 a[178:179], v25 offset:1544
    ds_read_b64_tr_b16 a[180:181], v25 offset:16
    ds_read_b64_tr_b16 a[182:183], v25 offset:1552
    ds_read_b64_tr_b16 a[184:185], v25 offset:3072
    ds_read_b64_tr_b16 a[186:187], v25 offset:4608
    ds_read_b64_tr_b16 a[188:189], v25 offset:3080
    ds_read_b64_tr_b16 a[190:191], v25 offset:4616
    ds_read_b64_tr_b16 a[192:193], v25 offset:3088
    ds_read_b64_tr_b16 a[194:195], v25 offset:4624
    ds_read_b64_tr_b16 a[196:197], v25 offset:6144
    ds_read_b64_tr_b16 a[198:199], v25 offset:7680
    ds_read_b64_tr_b16 a[200:201], v25 offset:6152
    ds_read_b64_tr_b16 a[202:203], v25 offset:7688
    ds_read_b64_tr_b16 a[204:205], v25 offset:6160
    ds_read_b64_tr_b16 a[206:207], v25 offset:7696
    ds_read_b64_tr_b16 a[208:209], v25 offset:9216
    ds_read_b64_tr_b16 a[210:211], v25 offset:10752
    ds_read_b64_tr_b16 a[212:213], v25 offset:9224
    ds_read_b64_tr_b16 a[214:215], v25 offset:10760
    ds_read_b64_tr_b16 a[216:217], v25 offset:9232
    ds_read_b64_tr_b16 a[218:219], v25 offset:10768
    ds_read_b64_tr_b16 a[220:221], v25 offset:12288
    ds_read_b64_tr_b16 a[222:223], v25 offset:13824
    ds_read_b64_tr_b16 a[224:225], v25 offset:12296
    ds_read_b64_tr_b16 a[226:227], v25 offset:13832
    ds_read_b64_tr_b16 a[228:229], v25 offset:12304
    ds_read_b64_tr_b16 a[230:231], v25 offset:13840
    s_waitcnt vmcnt(0)
    ds_read_b64_tr_b16 a[232:233], v25 offset:15360
    ds_read_b64_tr_b16 a[234:235], v25 offset:16896
    ds_read_b64_tr_b16 a[236:237], v25 offset:15368
    ds_read_b64_tr_b16 a[238:239], v25 offset:16904
    ds_read_b64_tr_b16 a[240:241], v25 offset:15376
    ds_read_b64_tr_b16 a[242:243], v25 offset:16912
    s_waitcnt lgkmcnt(15)
    s_add_u32 m0, s80, 0
    s_add_u32 s81, s3, 3
    s_and_b32 s81, s81, 3
    s_mul_i32 s81, s81, 88064
    s_add_u32 s81, s81, 1056768
    buffer_load_dwordx4 v17, s[36:39], s81 offen offset:0 lds
    buffer_load_dwordx4 v18, s[36:39], s81 offen offset:1024 lds
    buffer_load_dwordx4 v19, s[36:39], s81 offen offset:2048 lds
    s_add_u32 m0, s80, 3072
    s_cmp_ge_u32 s3, 4
    s_cselect_b32 s81, 360448, 0
    s_sub_u32 s81, s90, s81
    buffer_load_dwordx4 v20, s[40:43], s81 offen offset:0 lds
    buffer_load_dwordx4 v21, s[40:43], s81 offen offset:1024 lds
    buffer_load_dwordx4 v22, s[40:43], s81 offen offset:2048 lds
    buffer_load_dwordx4 v23, s[40:43], s81 offen offset:3072 lds
    s_waitcnt lgkmcnt(12)
    s_add_u32 m0, s80, 7168
    s_cmp_ge_u32 s3, 4
    s_cselect_b32 s81, 360448, 0
    s_sub_u32 s81, s90, s81
    s_add_u32 s81, s81, 32768
    buffer_load_dwordx4 v20, s[40:43], s81 offen offset:0 lds
    buffer_load_dwordx4 v21, s[40:43], s81 offen offset:1024 lds
    buffer_load_dwordx4 v22, s[40:43], s81 offen offset:2048 lds
    buffer_load_dwordx4 v23, s[40:43], s81 offen offset:3072 lds
    v_mov_b32 v96, s86
    v_mov_b32 v97, s86
    v_mov_b32 v98, s86
    v_mov_b32 v99, s86
    s_nop 1
    v_mfma_f32_16x16x32_bf16 v[112:115], a[64:67], v[96:99], 0
    v_mfma_f32_16x16x32_bf16 v[116:119], a[68:71], v[96:99], 0
    v_mfma_f32_16x16x32_bf16 v[120:123], a[72:75], v[96:99], 0
    v_mfma_f32_16x16x32_bf16 v[112:115], a[76:79], v[96:99], v[112:115]
    v_mfma_f32_16x16x32_bf16 v[116:119], a[80:83], v[96:99], v[116:119]
    v_mfma_f32_16x16x32_bf16 v[120:123], a[84:87], v[96:99], v[120:123]
    v_mfma_f32_16x16x32_bf16 v[112:115], a[88:91], v[96:99], v[112:115]
    v_mfma_f32_16x16x32_bf16 v[116:119], a[92:95], v[96:99], v[116:119]
    v_mfma_f32_16x16x32_bf16 v[120:123], a[96:99], v[96:99], v[120:123]
    v_mfma_f32_16x16x32_bf16 v[112:115], a[100:103], v[96:99], v[112:115]
    v_mfma_f32_16x16x32_bf16 v[116:119], a[104:107], v[96:99], v[116:119]
    v_mfma_f32_16x16x32_bf16 v[120:123], a[108:111], v[96:99], v[120:123]
    v_mfma_f32_16x16x32_bf16 v[112:115], a[112:115], v[96:99], v[112:115]
    v_mfma_f32_16x16x32_bf16 v[116:119], a[116:119], v[96:99], v[116:119]
    v_mfma_f32_16x16x32_bf16 v[120:123], a[120:123], v[96:99], v[120:123]
    v_mfma_f32_16x16x32_bf16 v[112:115], a[124:127], v[96:99], v[112:115]
    v_mfma_f32_16x16x32_bf16 v[116:119], a[128:131], v[96:99], v[116:119]
    v_mfma_f32_16x16x32_bf16 v[120:123], a[132:135], v[96:99], v[120:123]
    v_mfma_f32_16x16x32_bf16 v[112:115], a[136:139], v[96:99], v[112:115]
    v_mfma_f32_16x16x32_bf16 v[116:119], a[140:143], v[96:99], v[116:119]
    v_mfma_f32_16x16x32_bf16 v[120:123], a[144:147], v[96:99], v[120:123]
    v_mfma_f32_16x16x32_bf16 v[112:115], a[148:151], v[96:99], v[112:115]
    v_mfma_f32_16x16x32_bf16 v[116:119], a[152:155], v[96:99], v[116:119]
    v_mfma_f32_16x16x32_bf16 v[120:123], a[156:159], v[96:99], v[120:123]
    v_mfma_f32_16x16x32_bf16 v[112:115], a[160:163], v[96:99], v[112:115]
    v_mfma_f32_16x16x32_bf16 v[116:119], a[164:167], v[96:99], v[116:119]
    v_mfma_f32_16x16x32_bf16 v[120:123], a[168:171], v[96:99], v[120:123]
    v_mfma_f32_16x16x32_bf16 v[112:115], a[172:175], v[96:99], v[112:115]
    v_mfma_f32_16x16x32_bf16 v[116:119], a[176:179], v[96:99], v[116:119]
    v_mfma_f32_16x16x32_bf16 v[120:123], a[180:183], v[96:99], v[120:123]
    v_mfma_f32_16x16x32_bf16 v[112:115], a[184:187], v[96:99], v[112:115]
    v_mfma_f32_16x16x32_bf16 v[116:119], a[188:191], v[96:99], v[116:119]
    v_mfma_f32_16x16x32_bf16 v[120:123], a[192:195], v[96:99], v[120:123]
    v_mfma_f32_16x16x32_bf16 v[112:115], a[196:199], v[96:99], v[112:115]
    v_mfma_f32_16x16x32_bf16 v[116:119], a[200:203], v[96:99], v[116:119]
    v_mfma_f32_16x16x32_bf16 v[120:123], a[204:207], v[96:99], v[120:123]
    v_mfma_f32_16x16x32_bf16 v[112:115], a[208:211], v[96:99], v[112:115]
    v_mfma_f32_16x16x32_bf16 v[116:119], a[212:215], v[96:99], v[116:119]
    v_mfma_f32_16x16x32_bf16 v[120:123], a[216:219], v[96:99], v[120:123]
    s_waitcnt lgkmcnt(10)
    v_mfma_f32_16x16x32_bf16 v[112:115], a[220:223], v[96:99], v[112:115]
    s_waitcnt lgkmcnt(8)
    v_mfma_f32_16x16x32_bf16 v[116:119], a[224:227], v[96:99], v[116:119]
    s_waitcnt lgkmcnt(6)
    v_mfma_f32_16x16x32_bf16 v[120:123], a[228:231], v[96:99], v[120:123]
    s_waitcnt lgkmcnt(4)
    v_mfma_f32_16x16x32_bf16 v[112:115], a[232:235], v[96:99], v[112:115]
    s_waitcnt lgkmcnt(2)
    v_mfma_f32_16x16x32_bf16 v[116:119], a[236:239], v[96:99], v[116:119]
    s_waitcnt lgkmcnt(0)
    v_mfma_f32_16x16x32_bf16 v[120:123], a[240:243], v[96:99], v[120:123]
    s_mov_b32 s83, 0x40000
POLL_1:
    buffer_load_dwordx2 v[10:11], v13, s[60:63], s82 offen sc1
    s_waitcnt vmcnt(0)
    v_cmp_gt_u32 vcc, 2, v10
    s_nop 4
    s_cbranch_vccz DONE_1
    s_sub_u32 s83, s83, 1
    s_cmp_lg_u32 s83, 0
    s_cbranch_scc1 POLL_1
DONE_1:
    v_cmp_ne_u32 vcc, v11, v28
    s_nop 4
    s_cmp_eq_u64 vcc, 0
    s_cselect_b32 s2, 1, 0
    s_lshl_b32 s85, s64, 14
    s_add_u32 s84, s3, 0
    s_and_b32 s84, s84, 3
    s_lshl_b32 s84, s84, 10
    s_add_u32 s84, s84, s85
    s_add_u32 m0, s84, 0
    s_nop 0
    buffer_load_dwordx4 v6, s[56:59], s68 offen sc1 lds
    s_add_u32 m0, s84, 4096
    s_nop 0
    buffer_load_dwordx4 v6, s[56:59], s69 offen sc1 lds
    s_add_u32 m0, s84, 8192
    s_nop 0
    buffer_load_dwordx4 v6, s[56:59], s70 offen sc1 lds
    s_add_u32 m0, s84, 12288
    s_nop 0
    buffer_load_dwordx4 v6, s[56:59], s71 offen sc1 lds
    s_add_u32 s84, s3, 1
    s_and_b32 s84, s84, 3
    s_lshl_b32 s84, s84, 10
    s_add_u32 s84, s84, s85
    s_add_u32 m0, s84, 0
    s_nop 0
    buffer_load_dwordx4 v7, s[56:59], s68 offen sc1 lds
    s_add_u32 m0, s84, 4096
    s_nop 0
    buffer_load_dwordx4 v7, s[56:59], s69 offen sc1 lds
    s_add_u32 m0, s84, 8192
    s_nop 0
    buffer_load_dwordx4 v7, s[56:59], s70 offen sc1 lds
    s_add_u32 m0, s84, 12288
    s_nop 0
    buffer_load_dwordx4 v7, s[56:59], s71 offen sc1 lds
    s_add_u32 s84, s3, 2
    s_and_b32 s84, s84, 3
    s_lshl_b32 s84, s84, 10
    s_add_u32 s84, s84, s85
    s_add_u32 m0, s84, 0
    s_nop 0
    buffer_load_dwordx4 v8, s[56:59], s68 offen sc1 lds
    s_add_u32 m0, s84, 4096
    s_nop 0
    buffer_load_dwordx4 v8, s[56:59], s69 offen sc1 lds
    s_add_u32 m0, s84, 8192
    s_nop 0
    buffer_load_dwordx4 v8, s[56:59], s70 offen sc1 lds
    s_add_u32 m0, s84, 12288
    s_nop 0
    buffer_load_dwordx4 v8, s[56:59], s71 offen sc1 lds
    s_add_u32 s84, s3, 3
    s_and_b32 s84, s84, 3
    s_lshl_b32 s84, s84, 10
    s_add_u32 s84, s84, s85
    s_add_u32 m0, s84, 0
    s_nop 0
    buffer_load_dwordx4 v9, s[56:59], s68 offen sc1 lds
    s_add_u32 m0, s84, 4096
    s_nop 0
    buffer_load_dwordx4 v9, s[56:59], s69 offen sc1 lds
    s_add_u32 m0, s84, 8192
    s_nop 0
    buffer_load_dwordx4 v9, s[56:59], s70 offen sc1 lds
    s_add_u32 m0, s84, 12288
    s_nop 0
    buffer_load_dwordx4 v9, s[56:59], s71 offen sc1 lds
    s_lshl_b32 s84, s65, 12
    s_add_u32 s84, s84, 6164480
    buffer_load_dwordx2 v[220:221], v30, s[60:63], s84 offen offset:0 sc1
    buffer_load_dwordx2 v[222:223], v30, s[60:63], s84 offen offset:512 sc1
    buffer_load_dwordx2 v[224:225], v30, s[60:63], s84 offen offset:1024 sc1
    buffer_load_dwordx2 v[226:227], v30, s[60:63], s84 offen offset:1536 sc1
    buffer_load_dwordx2 v[228:229], v30, s[60:63], s84 offen offset:2048 sc1
    buffer_load_dwordx2 v[230:231], v30, s[60:63], s84 offen offset:2560 sc1
    buffer_load_dwordx2 v[232:233], v30, s[60:63], s84 offen offset:3072 sc1
    buffer_load_dwordx2 v[234:235], v30, s[60:63], s84 offen offset:3584 sc1
    s_waitcnt vmcnt(32)
    ds_read_b64_tr_b16 a[244:245], v25 offset:0
    ds_read_b64_tr_b16 a[246:247], v25 offset:1536
    ds_read_b64_tr_b16 a[248:249], v25 offset:8
    ds_read_b64_tr_b16 a[250:251], v25 offset:1544
    ds_read_b64_tr_b16 a[252:253], v25 offset:16
    ds_read_b64_tr_b16 a[254:255], v25 offset:1552
    s_waitcnt lgkmcnt(4)
    v_mfma_f32_16x16x32_bf16 v[112:115], a[244:247], v[96:99], v[112:115]
    s_waitcnt lgkmcnt(2)
    v_mfma_f32_16x16x32_bf16 v[116:119], a[248:251], v[96:99], v[116:119]
    s_waitcnt lgkmcnt(0)
    v_mfma_f32_16x16x32_bf16 v[120:123], a[252:255], v[96:99], v[120:123]
    s_waitcnt vmcnt(22)
    s_barrier
    ds_read_b128 v[80:83], v6 offset:0
    ds_read_b128 v[84:87], v6 offset:16384
    ds_read_b128 v[88:91], v6 offset:32768
    ds_read_b128 v[92:95], v6 offset:49152
    s_waitcnt lgkmcnt(0)
    v_mfma_f32_16x16x32_bf16 v[32:35], a[64:67], v[80:83], 0
    v_mfma_f32_16x16x32_bf16 v[36:39], a[68:71], v[80:83], 0
    ds_read_b128 v[96:99], v6 offset:4096
    v_mfma_f32_16x16x32_bf16 v[40:43], a[72:75], v[80:83], 0
    ds_read_b128 v[100:103], v6 offset:20480
    v_mfma_f32_16x16x32_bf16 v[44:47], a[64:67], v[84:87], 0
    ds_read_b128 v[104:107], v6 offset:36864
    v_mfma_f32_16x16x32_bf16 v[48:51], a[68:71], v[84:87], 0
    ds_read_b128 v[108:111], v6 offset:53248
    v_mfma_f32_16x16x32_bf16 v[52:55], a[72:75], v[84:87], 0
    v_mfma_f32_16x16x32_bf16 v[56:59], a[64:67], v[88:91], 0
    v_mfma_f32_16x16x32_bf16 v[60:63], a[68:71], v[88:91], 0
    v_mfma_f32_16x16x32_bf16 v[64:67], a[72:75], v[88:91], 0
    v_mfma_f32_16x16x32_bf16 v[68:71], a[64:67], v[92:95], 0
    v_mfma_f32_16x16x32_bf16 v[72:75], a[68:71], v[92:95], 0
    v_mfma_f32_16x16x32_bf16 v[76:79], a[72:75], v[92:95], 0
    s_waitcnt lgkmcnt(0)
    v_mfma_f32_16x16x32_bf16 v[32:35], a[76:79], v[96:99], v[32:35]
    s_waitcnt vmcnt(18)
    s_barrier
    v_mfma_f32_16x16x32_bf16 v[36:39], a[80:83], v[96:99], v[36:39]
    ds_read_b128 v[80:83], v6 offset:8192
    v_mfma_f32_16x16x32_bf16 v[40:43], a[84:87], v[96:99], v[40:43]
    ds_read_b128 v[84:87], v6 offset:24576
    v_mfma_f32_16x16x32_bf16 v[44:47], a[76:79], v[100:103], v[44:47]
    ds_read_b128 v[88:91], v6 offset:40960
    v_mfma_f32_16x16x32_bf16 v[48:51], a[80:83], v[100:103], v[48:51]
    ds_read_b128 v[92:95], v6 offset:57344
    v_mfma_f32_16x16x32_bf16 v[52:55], a[84:87], v[100:103], v[52:55]
    v_mfma_f32_16x16x32_bf16 v[56:59], a[76:79], v[104:107], v[56:59]
    v_mfma_f32_16x16x32_bf16 v[60:63], a[80:83], v[104:107], v[60:63]
    v_mfma_f32_16x16x32_bf16 v[64:67], a[84:87], v[104:107], v[64:67]
    v_mfma_f32_16x16x32_bf16 v[68:71], a[76:79], v[108:111], v[68:71]
    v_mfma_f32_16x16x32_bf16 v[72:75], a[80:83], v[108:111], v[72:75]
    v_mfma_f32_16x16x32_bf16 v[76:79], a[84:87], v[108:111], v[76:79]
    s_waitcnt lgkmcnt(0)
    v_mfma_f32_16x16x32_bf16 v[32:35], a[88:91], v[80:83], v[32:35]
    v_mfma_f32_16x16x32_bf16 v[36:39], a[92:95], v[80:83], v[36:39]
    ds_read_b128 v[96:99], v6 offset:12288
    s_add_u32 m0, s80, 11264
    s_cmp_ge_u32 s3, 3
    s_cselect_b32 s81, 360448, 0
    s_sub_u32 s81, s90, s81
    s_add_u32 s81, s81, 65536
    v_mfma_f32_16x16x32_bf16 v[40:43], a[96:99], v[80:83], v[40:43]
    ds_read_b128 v[100:103], v6 offset:28672
    buffer_load_dwordx4 v20, s[40:43], s81 offen offset:0 lds
    v_mfma_f32_16x16x32_bf16 v[44:47], a[88:91], v[84:87], v[44:47]
    ds_read_b128 v[104:107], v6 offset:45056
    buffer_load_dwordx4 v21, s[40:43], s81 offen offset:1024 lds
    v_mfma_f32_16x16x32_bf16 v[48:51], a[92:95], v[84:87], v[48:51]
    ds_read_b128 v[108:111], v6 offset:61440
    buffer_load_dwordx4 v22, s[40:43], s81 offen offset:2048 lds
    v_mfma_f32_16x16x32_bf16 v[52:55], a[96:99], v[84:87], v[52:55]
    v_mfma_f32_16x16x32_bf16 v[56:59], a[88:91], v[88:91], v[56:59]
    buffer_load_dwordx4 v23, s[40:43], s81 offen offset:3072 lds
    v_mfma_f32_16x16x32_bf16 v[60:63], a[92:95], v[88:91], v[60:63]
    v_mfma_f32_16x16x32_bf16 v[64:67], a[96:99], v[88:91], v[64:67]
    s_add_u32 m0, s80, 15360
    s_cmp_ge_u32 s3, 3
    s_cselect_b32 s81, 360448, 0
    s_sub_u32 s81, s90, s81
    s_add_u32 s81, s81, 98304
    v_mfma_f32_16x16x32_bf16 v[68:71], a[88:91], v[92:95], v[68:71]
    v_mfma_f32_16x16x32_bf16 v[72:75], a[92:95], v[92:95], v[72:75]
    buffer_load_dwordx4 v20, s[40:43], s81 offen offset:0 lds
    v_mfma_f32_16x16x32_bf16 v[76:79], a[96:99], v[92:95], v[76:79]
    s_waitcnt lgkmcnt(0)
    v_mfma_f32_16x16x32_bf16 v[32:35], a[100:103], v[96:99], v[32:35]
    buffer_load_dwordx4 v21, s[40:43], s81 offen offset:1024 lds
    v_mfma_f32_16x16x32_bf16 v[36:39], a[104:107], v[96:99], v[36:39]
    ds_read_b128 v[80:83], v7 offset:0
    buffer_load_dwordx4 v22, s[40:43], s81 offen offset:2048 lds
    v_mfma_f32_16x16x32_bf16 v[40:43], a[108:111], v[96:99], v[40:43]
    ds_read_b128 v[84:87], v7 offset:16384
    buffer_load_dwordx4 v23, s[40:43], s81 offen offset:3072 lds
    v_mfma_f32_16x16x32_bf16 v[44:47], a[100:103], v[100:103], v[44:47]
    ds_read_b128 v[88:91], v7 offset:32768
    v_mfma_f32_16x16x32_bf16 v[48:51], a[104:107], v[100:103], v[48:51]
    ds_read_b128 v[92:95], v7 offset:49152
    ds_read_b64_tr_b16 a[0:1], v26 offset:3072
    v_mfma_f32_16x16x32_bf16 v[52:55], a[108:111], v[100:103], v[52:55]
    v_mfma_f32_16x16x32_bf16 v[56:59], a[100:103], v[104:107], v[56:59]
    ds_read_b64_tr_b16 a[2:3], v26 offset:5120
    v_mfma_f32_16x16x32_bf16 v[60:63], a[104:107], v[104:107], v[60:63]
    v_mfma_f32_16x16x32_bf16 v[64:67], a[108:111], v[104:107], v[64:67]
    ds_read_b64_tr_b16 a[4:5], v26 offset:3080
    v_mfma_f32_16x16x32_bf16 v[68:71], a[100:103], v[108:111], v[68:71]
    v_mfma_f32_16x16x32_bf16 v[72:75], a[104:107], v[108:111], v[72:75]
    ds_read_b64_tr_b16 a[6:7], v26 offset:5128
    v_mfma_f32_16x16x32_bf16 v[76:79], a[108:111], v[108:111], v[76:79]
    s_waitcnt lgkmcnt(0)
    v_mfma_f32_16x16x32_bf16 v[32:35], a[112:115], v[80:83], v[32:35]
    ds_read_b64_tr_b16 a[8:9], v27 offset:3072
    v_mfma_f32_16x16x32_bf16 v[36:39], a[116:119], v[80:83], v[36:39]
    ds_read_b128 v[96:99], v7 offset:4096
    ds_read_b64_tr_b16 a[10:11], v27 offset:5120
    v_mfma_f32_16x16x32_bf16 v[40:43], a[120:123], v[80:83], v[40:43]
    ds_read_b128 v[100:103], v7 offset:20480
    ds_read_b64_tr_b16 a[12:13], v27 offset:3080
    v_mfma_f32_16x16x32_bf16 v[44:47], a[112:115], v[84:87], v[44:47]
    ds_read_b128 v[104:107], v7 offset:36864
    ds_read_b64_tr_b16 a[14:15], v27 offset:5128
    v_mfma_f32_16x16x32_bf16 v[48:51], a[116:119], v[84:87], v[48:51]
    ds_read_b128 v[108:111], v7 offset:53248
    s_waitcnt lgkmcnt(1)
    s_add_u32 m0, s80, 0
    s_cmp_ge_u32 s3, 3
    s_cselect_b32 s81, 360448, 0
    s_sub_u32 s81, s90, s81
    s_add_u32 s81, s81, 131072
    v_mfma_f32_16x16x32_bf16 v[52:55], a[120:123], v[84:87], v[52:55]
    v_mfma_f32_16x16x32_bf16 v[56:59], a[112:115], v[88:91], v[56:59]
    buffer_load_dwordx4 v20, s[40:43], s81 offen offset:0 lds
    v_mfma_f32_16x16x32_bf16 v[60:63], a[116:119], v[88:91], v[60:63]
    v_mfma_f32_16x16x32_bf16 v[64:67], a[120:123], v[88:91], v[64:67]
    buffer_load_dwordx4 v21, s[40:43], s81 offen offset:1024 lds
    v_mfma_f32_16x16x32_bf16 v[68:71], a[112:115], v[92:95], v[68:71]
    v_mfma_f32_16x16x32_bf16 v[72:75], a[116:119], v[92:95], v[72:75]
    buffer_load_dwordx4 v22, s[40:43], s81 offen offset:2048 lds
    v_mfma_f32_16x16x32_bf16 v[76:79], a[120:123], v[92:95], v[76:79]
    s_waitcnt lgkmcnt(0)
    v_mfma_f32_16x16x32_bf16 v[32:35], a[124:127], v[96:99], v[32:35]
    buffer_load_dwordx4 v23, s[40:43], s81 offen offset:3072 lds
    s_waitcnt vmcnt(20)
    s_barrier
    v_mfma_f32_16x16x32_bf16 v[36:39], a[128:131], v[96:99], v[36:39]
    ds_read_b128 v[80:83], v7 offset:8192
    v_mfma_f32_16x16x32_bf16 v[40:43], a[132:135], v[96:99], v[40:43]
    ds_read_b64_tr_b16 a[16:17], v26 offset:7168
    ds_read_b128 v[84:87], v7 offset:24576
    v_mfma_f32_16x16x32_bf16 v[44:47], a[124:127], v[100:103], v[44:47]
    ds_read_b64_tr_b16 a[18:19], v26 offset:9216
    ds_read_b128 v[88:91], v7 offset:40960
    v_mfma_f32_16x16x32_bf16 v[48:51], a[128:131], v[100:103], v[48:51]
    ds_read_b64_tr_b16 a[20:21], v26 offset:7176
    ds_read_b128 v[92:95], v7 offset:57344
    v_mfma_f32_16x16x32_bf16 v[52:55], a[132:135], v[100:103], v[52:55]
    ds_read_b64_tr_b16 a[22:23], v26 offset:9224
    v_mfma_f32_16x16x32_bf16 v[56:59], a[124:127], v[104:107], v[56:59]
    v_mfma_f32_16x16x32_bf16 v[60:63], a[128:131], v[104:107], v[60:63]
    ds_read_b64_tr_b16 a[24:25], v27 offset:7168
    v_mfma_f32_16x16x32_bf16 v[64:67], a[132:135], v[104:107], v[64:67]
    v_mfma_f32_16x16x32_bf16 v[68:71], a[124:127], v[108:111], v[68:71]
    ds_read_b64_tr_b16 a[26:27], v27 offset:9216
    v_mfma_f32_16x16x32_bf16 v[72:75], a[128:131], v[108:111], v[72:75]
    v_mfma_f32_16x16x32_bf16 v[76:79], a[132:135], v[108:111], v[76:79]
    ds_read_b64_tr_b16 a[28:29], v27 offset:7176
    s_waitcnt lgkmcnt(0)
    v_mfma_f32_16x16x32_bf16 v[32:35], a[136:139], v[80:83], v[32:35]
    v_mfma_f32_16x16x32_bf16 v[36:39], a[140:143], v[80:83], v[36:39]
    ds_read_b64_tr_b16 a[30:31], v27 offset:9224
    ds_read_b128 v[96:99], v7 offset:12288
    v_mfma_f32_16x16x32_bf16 v[40:43], a[144:147], v[80:83], v[40:43]
    s_waitcnt lgkmcnt(1)
    s_add_u32 m0, s80, 4096
    s_cmp_ge_u32 s3, 2
    s_cselect_b32 s81, 360448, 0
    s_sub_u32 s81, s90, s81
    s_add_u32 s81, s81, 163840
    ds_read_b128 v[100:103], v7 offset:28672
    v_mfma_f32_16x16x32_bf16 v[44:47], a[136:139], v[84:87], v[44:47]
    buffer_load_dwordx4 v20, s[40:43], s81 offen offset:0 lds
    ds_read_b128 v[104:107], v7 offset:45056
    v_mfma_f32_16x16x32_bf16 v[48:51], a[140:143], v[84:87], v[48:51]
    buffer_load_dwordx4 v21, s[40:43], s81 offen offset:1024 lds
    ds_read_b128 v[108:111], v7 offset:61440
    v_mfma_f32_16x16x32_bf16 v[52:55], a[144:147], v[84:87], v[52:55]
    buffer_load_dwordx4 v22, s[40:43], s81 offen offset:2048 lds
    v_mfma_f32_16x16x32_bf16 v[56:59], a[136:139], v[88:91], v[56:59]
    v_mfma_f32_16x16x32_bf16 v[60:63], a[140:143], v[88:91], v[60:63]
    buffer_load_dwordx4 v23, s[40:43], s81 offen offset:3072 lds
    v_mfma_f32_16x16x32_bf16 v[64:67], a[144:147], v[88:91], v[64:67]
    v_mfma_f32_16x16x32_bf16 v[68:71], a[136:139], v[92:95], v[68:71]
    s_waitcnt vmcnt(12)
    v_mfma_f32_16x16x32_bf16 v[72:75], a[140:143], v[92:95], v[72:75]
    v_mfma_f32_16x16x32_bf16 v[76:79], a[144:147], v[92:95], v[76:79]
    ds_read_b64_tr_b16 a[32:33], v26 offset:11264
    s_waitcnt lgkmcnt(0)
    v_mfma_f32_16x16x32_bf16 v[32:35], a[148:151], v[96:99], v[32:35]
    v_mfma_f32_16x16x32_bf16 v[36:39], a[152:155], v[96:99], v[36:39]
    ds_read_b64_tr_b16 a[34:35], v26 offset:13312
    ds_read_b128 v[80:83], v8 offset:0
    v_mfma_f32_16x16x32_bf16 v[40:43], a[156:159], v[96:99], v[40:43]
    ds_read_b64_tr_b16 a[36:37], v26 offset:11272
    ds_read_b128 v[84:87], v8 offset:16384
    v_mfma_f32_16x16x32_bf16 v[44:47], a[148:151], v[100:103], v[44:47]
    ds_read_b64_tr_b16 a[38:39], v26 offset:13320
    ds_read_b128 v[88:91], v8 offset:32768
    v_mfma_f32_16x16x32_bf16 v[48:51], a[152:155], v[100:103], v[48:51]
    ds_read_b64_tr_b16 a[40:41], v27 offset:11264
    ds_read_b128 v[92:95], v8 offset:49152
    v_mfma_f32_16x16x32_bf16 v[52:55], a[156:159], v[100:103], v[52:55]
    ds_read_b64_tr_b16 a[42:43], v27 offset:13312
    v_pk_add_f32 v[220:221], v[220:221], v[222:223]
    v_mfma_f32_16x16x32_bf16 v[56:59], a[148:151], v[104:107], v[56:59]
    ds_read_b64_tr_b16 a[44:45], v27 offset:11272
    v_pk_add_f32 v[224:225], v[224:225], v[226:227]
    v_mfma_f32_16x16x32_bf16 v[60:63], a[152:155], v[104:107], v[60:63]
    ds_read_b64_tr_b16 a[46:47], v27 offset:13320
    v_pk_add_f32 v[228:229], v[228:229], v[230:231]
    v_mfma_f32_16x16x32_bf16 v[64:67], a[156:159], v[104:107], v[64:67]
    s_waitcnt lgkmcnt(0)
    s_add_u32 m0, s80, 8192
    s_cmp_ge_u32 s3, 2
    s_cselect_b32 s81, 360448, 0
    s_sub_u32 s81, s90, s81
    s_add_u32 s81, s81, 196608
    v_pk_add_f32 v[232:233], v[232:233], v[234:235]
    v_mfma_f32_16x16x32_bf16 v[68:71], a[148:151], v[108:111], v[68:71]
    buffer_load_dwordx4 v20, s[40:43], s81 offen offset:0 lds
    v_pk_add_f32 v[220:221], v[220:221], v[224:225]
    v_mfma_f32_16x16x32_bf16 v[72:75], a[152:155], v[108:111], v[72:75]
    buffer_load_dwordx4 v21, s[40:43], s81 offen offset:1024 lds
    v_pk_add_f32 v[228:229], v[228:229], v[232:233]
    v_mfma_f32_16x16x32_bf16 v[76:79], a[156:159], v[108:111], v[76:79]
    buffer_load_dwordx4 v22, s[40:43], s81 offen offset:2048 lds
    v_mfma_f32_16x16x32_bf16 v[32:35], a[160:163], v[80:83], v[32:35]
    v_mfma_f32_16x16x32_bf16 v[36:39], a[164:167], v[80:83], v[36:39]
    buffer_load_dwordx4 v23, s[40:43], s81 offen offset:3072 lds
    ds_read_b128 v[96:99], v8 offset:4096
    v_mfma_f32_16x16x32_bf16 v[40:43], a[168:171], v[80:83], v[40:43]
    s_waitcnt vmcnt(12)
    ds_read_b128 v[100:103], v8 offset:20480
    v_mfma_f32_16x16x32_bf16 v[44:47], a[160:163], v[84:87], v[44:47]
    ds_read_b64_tr_b16 a[48:49], v26 offset:15360
    ds_read_b128 v[104:107], v8 offset:36864
    v_mfma_f32_16x16x32_bf16 v[48:51], a[164:167], v[84:87], v[48:51]
    ds_read_b64_tr_b16 a[50:51], v26 offset:17408
    ds_read_b128 v[108:111], v8 offset:53248
    v_mfma_f32_16x16x32_bf16 v[52:55], a[168:171], v[84:87], v[52:55]
    ds_read_b64_tr_b16 a[52:53], v26 offset:15368
    v_pk_add_f32 v[246:247], v[220:221], v[228:229]
    v_mfma_f32_16x16x32_bf16 v[56:59], a[160:163], v[88:91], v[56:59]
    ds_read_b64_tr_b16 a[54:55], v26 offset:17416
    v_mul_f32 v246, 0xbb000000, v246
    v_mfma_f32_16x16x32_bf16 v[60:63], a[164:167], v[88:91], v[60:63]
    ds_read_b64_tr_b16 a[56:57], v27 offset:15360
    v_mul_f32 v247, 0x3b000000, v247
    v_mfma_f32_16x16x32_bf16 v[64:67], a[168:171], v[88:91], v[64:67]
    ds_read_b64_tr_b16 a[58:59], v27 offset:17408
    v_fma_f32 v247, -v246, v246, v247
    v_mfma_f32_16x16x32_bf16 v[68:71], a[160:163], v[92:95], v[68:71]
    ds_read_b64_tr_b16 a[60:61], v27 offset:15368
    v_max_f32 v247, 0, v247
    v_mfma_f32_16x16x32_bf16 v[72:75], a[164:167], v[92:95], v[72:75]
    ds_read_b64_tr_b16 a[62:63], v27 offset:17416
    v_add_f32 v247, 0x3727c5ac, v247
    v_mfma_f32_16x16x32_bf16 v[76:79], a[168:171], v[92:95], v[76:79]
    s_waitcnt lgkmcnt(0)
    s_add_u32 m0, s80, 12288
    s_cmp_ge_u32 s3, 2
    s_cselect_b32 s81, 360448, 0
    s_sub_u32 s81, s90, s81
    s_add_u32 s81, s81, 229376
    v_mfma_f32_16x16x32_bf16 v[32:35], a[172:175], v[96:99], v[32:35]
    v_mfma_f32_16x16x32_bf16 v[36:39], a[176:179], v[96:99], v[36:39]
    buffer_load_dwordx4 v20, s[40:43], s81 offen offset:0 lds
    ds_read_b128 v[80:83], v8 offset:8192
    v_mfma_f32_16x16x32_bf16 v[40:43], a[180:183], v[96:99], v[40:43]
    buffer_load_dwordx4 v21, s[40:43], s81 offen offset:1024 lds
    ds_read_b128 v[84:87], v8 offset:24576
    v_mfma_f32_16x16x32_bf16 v[44:47], a[172:175], v[100:103], v[44:47]
    buffer_load_dwordx4 v22, s[40:43], s81 offen offset:2048 lds
    ds_read_b128 v[88:91], v8 offset:40960
    v_mfma_f32_16x16x32_bf16 v[48:51], a[176:179], v[100:103], v[48:51]
    buffer_load_dwordx4 v23, s[40:43], s81 offen offset:3072 lds
    ds_read_b128 v[92:95], v8 offset:57344
    v_mfma_f32_16x16x32_bf16 v[52:55], a[180:183], v[100:103], v[52:55]
    s_waitcnt vmcnt(12)
    v_rsq_f32 v247, v247
    v_mfma_f32_16x16x32_bf16 v[56:59], a[172:175], v[104:107], v[56:59]
    ds_read_b64_tr_b16 v[124:125], v26 offset:0
    ds_write_b64 v30, v[246:247]
    v_mfma_f32_16x16x32_bf16 v[60:63], a[176:179], v[104:107], v[60:63]
    ds_read_b64_tr_b16 v[126:127], v26 offset:2048
    v_mfma_f32_16x16x32_bf16 v[64:67], a[180:183], v[104:107], v[64:67]
    v_mfma_f32_16x16x32_bf16 v[68:71], a[172:175], v[108:111], v[68:71]
    ds_read_b64_tr_b16 v[128:129], v26 offset:8
    v_mfma_f32_16x16x32_bf16 v[72:75], a[176:179], v[108:111], v[72:75]
    v_mfma_f32_16x16x32_bf16 v[76:79], a[180:183], v[108:111], v[76:79]
    ds_read_b64_tr_b16 v[130:131], v26 offset:2056
    s_waitcnt lgkmcnt(0)
    v_mfma_f32_16x16x32_bf16 v[32:35], a[184:187], v[80:83], v[32:35]
    v_mfma_f32_16x16x32_bf16 v[36:39], a[188:191], v[80:83], v[36:39]
    ds_read_b64_tr_b16 v[132:133], v27 offset:0
    ds_read_b128 v[96:99], v8 offset:12288
    v_mfma_f32_16x16x32_bf16 v[40:43], a[192:195], v[80:83], v[40:43]
    ds_read_b64_tr_b16 v[134:135], v27 offset:2048
    ds_read_b128 v[100:103], v8 offset:28672
    v_mfma_f32_16x16x32_bf16 v[44:47], a[184:187], v[84:87], v[44:47]
    ds_read_b64_tr_b16 v[136:137], v27 offset:8
    ds_read_b128 v[104:107], v8 offset:45056
    v_mfma_f32_16x16x32_bf16 v[48:51], a[188:191], v[84:87], v[48:51]
    ds_read_b64_tr_b16 v[138:139], v27 offset:2056
    ds_read_b128 v[108:111], v8 offset:61440
    v_mfma_f32_16x16x32_bf16 v[52:55], a[192:195], v[84:87], v[52:55]
    s_waitcnt lgkmcnt(1)
    s_add_u32 m0, s80, 0
    s_cmp_ge_u32 s3, 1
    s_cselect_b32 s81, 360448, 0
    s_sub_u32 s81, s90, s81
    s_add_u32 s81, s81, 262144
    v_mfma_f32_16x16x32_bf16 v[56:59], a[184:187], v[88:91], v[56:59]
    v_mfma_f32_16x16x32_bf16 v[60:63], a[188:191], v[88:91], v[60:63]
    buffer_load_dwordx4 v20, s[40:43], s81 offen offset:0 lds
    v_mfma_f32_16x16x32_bf16 v[64:67], a[192:195], v[88:91], v[64:67]
    v_mfma_f32_16x16x32_bf16 v[68:71], a[184:187], v[92:95], v[68:71]
    buffer_load_dwordx4 v21, s[40:43], s81 offen offset:1024 lds
    v_mfma_f32_16x16x32_bf16 v[72:75], a[188:191], v[92:95], v[72:75]
    v_mfma_f32_16x16x32_bf16 v[76:79], a[192:195], v[92:95], v[76:79]
    buffer_load_dwordx4 v22, s[40:43], s81 offen offset:2048 lds
    s_waitcnt lgkmcnt(0)
    v_mfma_f32_16x16x32_bf16 v[32:35], a[196:199], v[96:99], v[32:35]
    v_mfma_f32_16x16x32_bf16 v[36:39], a[200:203], v[96:99], v[36:39]
    buffer_load_dwordx4 v23, s[40:43], s81 offen offset:3072 lds
    ds_read_b128 v[80:83], v9 offset:0
    v_mfma_f32_16x16x32_bf16 v[40:43], a[204:207], v[96:99], v[40:43]
    s_waitcnt vmcnt(12)
    ds_read_b128 v[84:87], v9 offset:16384
    v_mfma_f32_16x16x32_bf16 v[44:47], a[196:199], v[100:103], v[44:47]
    ds_read_b64_tr_b16 v[140:141], v26 offset:4096
    ds_read_b128 v[88:91], v9 offset:32768
    v_mfma_f32_16x16x32_bf16 v[48:51], a[200:203], v[100:103], v[48:51]
    ds_read_b64_tr_b16 v[142:143], v26 offset:6144
    ds_read_b128 v[92:95], v9 offset:49152
    v_mfma_f32_16x16x32_bf16 v[52:55], a[204:207], v[100:103], v[52:55]
    ds_read_b64_tr_b16 v[144:145], v26 offset:4104
    v_mfma_f32_16x16x32_bf16 v[56:59], a[196:199], v[104:107], v[56:59]
    v_mfma_f32_16x16x32_bf16 v[60:63], a[200:203], v[104:107], v[60:63]
    ds_read_b64_tr_b16 v[146:147], v26 offset:6152
    v_mfma_f32_16x16x32_bf16 v[64:67], a[204:207], v[104:107], v[64:67]
    v_mfma_f32_16x16x32_bf16 v[68:71], a[196:199], v[108:111], v[68:71]
    ds_read_b64_tr_b16 v[148:149], v27 offset:4096
    v_mfma_f32_16x16x32_bf16 v[72:75], a[200:203], v[108:111], v[72:75]
    v_mfma_f32_16x16x32_bf16 v[76:79], a[204:207], v[108:111], v[76:79]
    ds_read_b64_tr_b16 v[150:151], v27 offset:6144
    s_waitcnt lgkmcnt(0)
    v_mfma_f32_16x16x32_bf16 v[32:35], a[208:211], v[80:83], v[32:35]
    v_mfma_f32_16x16x32_bf16 v[36:39], a[212:215], v[80:83], v[36:39]
    ds_read_b64_tr_b16 v[152:153], v27 offset:4104
    ds_read_b128 v[96:99], v9 offset:4096
    v_mfma_f32_16x16x32_bf16 v[40:43], a[216:219], v[80:83], v[40:43]
    ds_read_b64_tr_b16 v[154:155], v27 offset:6152
    ds_read_b128 v[100:103], v9 offset:20480
    v_mfma_f32_16x16x32_bf16 v[44:47], a[208:211], v[84:87], v[44:47]
    s_waitcnt lgkmcnt(1)
    s_add_u32 m0, s80, 4096
    s_cmp_ge_u32 s3, 1
    s_cselect_b32 s81, 360448, 0
    s_sub_u32 s81, s90, s81
    s_add_u32 s81, s81, 294912
    ds_read_b128 v[104:107], v9 offset:36864
    v_mfma_f32_16x16x32_bf16 v[48:51], a[212:215], v[84:87], v[48:51]
    buffer_load_dwordx4 v20, s[40:43], s81 offen offset:0 lds
    ds_read_b128 v[108:111], v9 offset:53248
    v_mfma_f32_16x16x32_bf16 v[52:55], a[216:219], v[84:87], v[52:55]
    buffer_load_dwordx4 v21, s[40:43], s81 offen offset:1024 lds
    ds_read_b64 v[246:247], v29 offset:0
    v_mfma_f32_16x16x32_bf16 v[56:59], a[208:211], v[88:91], v[56:59]
    buffer_load_dwordx4 v22, s[40:43], s81 offen offset:2048 lds
    ds_read_b64 v[248:249], v29 offset:128
    v_mfma_f32_16x16x32_bf16 v[60:63], a[212:215], v[88:91], v[60:63]
    buffer_load_dwordx4 v23, s[40:43], s81 offen offset:3072 lds
    ds_read_b64 v[250:251], v29 offset:256
    v_mfma_f32_16x16x32_bf16 v[64:67], a[216:219], v[88:91], v[64:67]
    s_waitcnt vmcnt(12)
    ds_read_b64 v[252:253], v29 offset:384
    v_mfma_f32_16x16x32_bf16 v[68:71], a[208:211], v[92:95], v[68:71]
    ds_read_b64_tr_b16 v[156:157], v26 offset:8192
    v_mfma_f32_16x16x32_bf16 v[72:75], a[212:215], v[92:95], v[72:75]
    v_mfma_f32_16x16x32_bf16 v[76:79], a[216:219], v[92:95], v[76:79]
    ds_read_b64_tr_b16 v[158:159], v26 offset:10240
    s_waitcnt lgkmcnt(0)
    v_mfma_f32_16x16x32_bf16 v[32:35], a[220:223], v[96:99], v[32:35]
    v_mfma_f32_16x16x32_bf16 v[36:39], a[224:227], v[96:99], v[36:39]
    ds_read_b64_tr_b16 v[160:161], v26 offset:8200
    ds_read_b128 v[80:83], v9 offset:8192
    v_mfma_f32_16x16x32_bf16 v[40:43], a[228:231], v[96:99], v[40:43]
    ds_read_b64_tr_b16 v[162:163], v26 offset:10248
    ds_read_b128 v[84:87], v9 offset:24576
    v_mfma_f32_16x16x32_bf16 v[44:47], a[220:223], v[100:103], v[44:47]
    ds_read_b64_tr_b16 v[164:165], v27 offset:8192
    ds_read_b128 v[88:91], v9 offset:40960
    v_mfma_f32_16x16x32_bf16 v[48:51], a[224:227], v[100:103], v[48:51]
    ds_read_b64_tr_b16 v[166:167], v27 offset:10240
    ds_read_b128 v[92:95], v9 offset:57344
    v_mfma_f32_16x16x32_bf16 v[52:55], a[228:231], v[100:103], v[52:55]
    ds_read_b64_tr_b16 v[168:169], v27 offset:8200
    v_mfma_f32_16x16x32_bf16 v[56:59], a[220:223], v[104:107], v[56:59]
    v_mfma_f32_16x16x32_bf16 v[60:63], a[224:227], v[104:107], v[60:63]
    ds_read_b64_tr_b16 v[170:171], v27 offset:10248
    v_mfma_f32_16x16x32_bf16 v[64:67], a[228:231], v[104:107], v[64:67]
    v_mfma_f32_16x16x32_bf16 v[68:71], a[220:223], v[108:111], v[68:71]
    s_waitcnt lgkmcnt(0)
    s_add_u32 m0, s80, 8192
    s_cmp_ge_u32 s3, 1
    s_cselect_b32 s81, 360448, 0
    s_sub_u32 s81, s90, s81
    s_add_u32 s81, s81, 327680
    v_mfma_f32_16x16x32_bf16 v[72:75], a[224:227], v[108:111], v[72:75]
    v_mfma_f32_16x16x32_bf16 v[76:79], a[228:231], v[108:111], v[76:79]
    buffer_load_dwordx4 v20, s[40:43], s81 offen offset:0 lds
    v_mfma_f32_16x16x32_bf16 v[32:35], a[232:235], v[80:83], v[32:35]
    v_mfma_f32_16x16x32_bf16 v[36:39], a[236:239], v[80:83], v[36:39]
    buffer_load_dwordx4 v21, s[40:43], s81 offen offset:1024 lds
    ds_read_b128 v[96:99], v9 offset:12288
    v_mfma_f32_16x16x32_bf16 v[40:43], a[240:243], v[80:83], v[40:43]
    buffer_load_dwordx4 v22, s[40:43], s81 offen offset:2048 lds
    ds_read_b128 v[100:103], v9 offset:28672
    v_mfma_f32_16x16x32_bf16 v[44:47], a[232:235], v[84:87], v[44:47]
    buffer_load_dwordx4 v23, s[40:43], s81 offen offset:3072 lds
    ds_read_b128 v[104:107], v9 offset:45056
    v_mfma_f32_16x16x32_bf16 v[48:51], a[236:239], v[84:87], v[48:51]
    s_waitcnt vmcnt(12)
    ds_read_b128 v[108:111], v9 offset:61440
    v_mfma_f32_16x16x32_bf16 v[52:55], a[240:243], v[84:87], v[52:55]
    ds_read_b64_tr_b16 v[172:173], v26 offset:12288
    v_mfma_f32_16x16x32_bf16 v[56:59], a[232:235], v[88:91], v[56:59]
    v_mfma_f32_16x16x32_bf16 v[60:63], a[236:239], v[88:91], v[60:63]
    ds_read_b64_tr_b16 v[174:175], v26 offset:14336
    v_mfma_f32_16x16x32_bf16 v[64:67], a[240:243], v[88:91], v[64:67]
    v_mfma_f32_16x16x32_bf16 v[68:71], a[232:235], v[92:95], v[68:71]
    ds_read_b64_tr_b16 v[176:177], v26 offset:12296
    v_mfma_f32_16x16x32_bf16 v[72:75], a[236:239], v[92:95], v[72:75]
    v_mfma_f32_16x16x32_bf16 v[76:79], a[240:243], v[92:95], v[76:79]
    ds_read_b64_tr_b16 v[178:179], v26 offset:14344
    s_waitcnt lgkmcnt(0)
    v_mfma_f32_16x16x32_bf16 v[32:35], a[244:247], v[96:99], v[32:35]
    v_mfma_f32_16x16x32_bf16 v[36:39], a[248:251], v[96:99], v[36:39]
    ds_read_b64_tr_b16 v[180:181], v27 offset:12288
    v_mfma_f32_16x16x32_bf16 v[40:43], a[252:255], v[96:99], v[40:43]
    v_mfma_f32_16x16x32_bf16 v[44:47], a[244:247], v[100:103], v[44:47]
    ds_read_b64_tr_b16 v[182:183], v27 offset:14336
    v_mfma_f32_16x16x32_bf16 v[48:51], a[248:251], v[100:103], v[48:51]
    v_mfma_f32_16x16x32_bf16 v[52:55], a[252:255], v[100:103], v[52:55]
    ds_read_b64_tr_b16 v[184:185], v27 offset:12296
    v_mfma_f32_16x16x32_bf16 v[56:59], a[244:247], v[104:107], v[56:59]
    v_mfma_f32_16x16x32_bf16 v[60:63], a[248:251], v[104:107], v[60:63]
    ds_read_b64_tr_b16 v[186:187], v27 offset:14344
    v_mfma_f32_16x16x32_bf16 v[64:67], a[252:255], v[104:107], v[64:67]
    v_mfma_f32_16x16x32_bf16 v[68:71], a[244:247], v[108:111], v[68:71]
    s_waitcnt vmcnt(8)
    v_mfma_f32_16x16x32_bf16 v[72:75], a[248:251], v[108:111], v[72:75]
    v_mfma_f32_16x16x32_bf16 v[76:79], a[252:255], v[108:111], v[76:79]
    ds_read_b64_tr_b16 v[188:189], v26 offset:0
    ds_read_b64_tr_b16 v[190:191], v26 offset:2048
    ds_read_b64_tr_b16 v[192:193], v26 offset:8
    ds_read_b64_tr_b16 v[194:195], v26 offset:2056
    ds_read_b64_tr_b16 v[196:197], v27 offset:0
    ds_read_b64_tr_b16 v[198:199], v27 offset:2048
    ds_read_b64_tr_b16 v[200:201], v27 offset:8
    ds_read_b64_tr_b16 v[202:203], v27 offset:2056
    v_pk_fma_f32 v[32:33], v[112:113], v[246:247], v[32:33] op_sel:[0,0,0] op_sel_hi:[1,0,1]
    v_pk_fma_f32 v[34:35], v[114:115], v[246:247], v[34:35] op_sel:[0,0,0] op_sel_hi:[1,0,1]
    v_pk_fma_f32 v[36:37], v[116:117], v[246:247], v[36:37] op_sel:[0,0,0] op_sel_hi:[1,0,1]
    v_pk_fma_f32 v[38:39], v[118:119], v[246:247], v[38:39] op_sel:[0,0,0] op_sel_hi:[1,0,1]
    v_pk_fma_f32 v[40:41], v[120:121], v[246:247], v[40:41] op_sel:[0,0,0] op_sel_hi:[1,0,1]
    v_pk_fma_f32 v[42:43], v[122:123], v[246:247], v[42:43] op_sel:[0,0,0] op_sel_hi:[1,0,1]
    v_pk_mul_f32 v[32:33], v[32:33], v[246:247] op_sel:[0,1] op_sel_hi:[1,1]
    v_pk_mul_f32 v[34:35], v[34:35], v[246:247] op_sel:[0,1] op_sel_hi:[1,1]
    v_pk_mul_f32 v[36:37], v[36:37], v[246:247] op_sel:[0,1] op_sel_hi:[1,1]
    v_pk_mul_f32 v[38:39], v[38:39], v[246:247] op_sel:[0,1] op_sel_hi:[1,1]
    v_pk_mul_f32 v[40:41], v[40:41], v[246:247] op_sel:[0,1] op_sel_hi:[1,1]
    v_pk_mul_f32 v[42:43], v[42:43], v[246:247] op_sel:[0,1] op_sel_hi:[1,1]
    v_cvt_pk_bf16_f32 v80, v32, v33
    v_cvt_pk_bf16_f32 v81, v34, v35
    v_cvt_pk_bf16_f32 v82, v36, v37
    v_cvt_pk_bf16_f32 v83, v38, v39
    v_cvt_pk_bf16_f32 v84, v40, v41
    v_cvt_pk_bf16_f32 v85, v42, v43
    v_pk_max_i16 v80, v80, 0
    v_pk_max_i16 v81, v81, 0
    v_pk_max_i16 v82, v82, 0
    v_pk_max_i16 v83, v83, 0
    v_pk_max_i16 v84, v84, 0
    v_pk_max_i16 v85, v85, 0
    v_pk_fma_f32 v[44:45], v[112:113], v[248:249], v[44:45] op_sel:[0,0,0] op_sel_hi:[1,0,1]
    v_pk_fma_f32 v[46:47], v[114:115], v[248:249], v[46:47] op_sel:[0,0,0] op_sel_hi:[1,0,1]
    v_pk_fma_f32 v[48:49], v[116:117], v[248:249], v[48:49] op_sel:[0,0,0] op_sel_hi:[1,0,1]
    v_pk_fma_f32 v[50:51], v[118:119], v[248:249], v[50:51] op_sel:[0,0,0] op_sel_hi:[1,0,1]
    v_pk_fma_f32 v[52:53], v[120:121], v[248:249], v[52:53] op_sel:[0,0,0] op_sel_hi:[1,0,1]
    v_pk_fma_f32 v[54:55], v[122:123], v[248:249], v[54:55] op_sel:[0,0,0] op_sel_hi:[1,0,1]
    v_pk_mul_f32 v[44:45], v[44:45], v[248:249] op_sel:[0,1] op_sel_hi:[1,1]
    v_pk_mul_f32 v[46:47], v[46:47], v[248:249] op_sel:[0,1] op_sel_hi:[1,1]
    v_pk_mul_f32 v[48:49], v[48:49], v[248:249] op_sel:[0,1] op_sel_hi:[1,1]
    v_pk_mul_f32 v[50:51], v[50:51], v[248:249] op_sel:[0,1] op_sel_hi:[1,1]
    v_pk_mul_f32 v[52:53], v[52:53], v[248:249] op_sel:[0,1] op_sel_hi:[1,1]
    v_pk_mul_f32 v[54:55], v[54:55], v[248:249] op_sel:[0,1] op_sel_hi:[1,1]
    v_cvt_pk_bf16_f32 v86, v44, v45
    v_cvt_pk_bf16_f32 v87, v46, v47
    v_cvt_pk_bf16_f32 v88, v48, v49
    v_cvt_pk_bf16_f32 v89, v50, v51
    v_cvt_pk_bf16_f32 v90, v52, v53
    v_cvt_pk_bf16_f32 v91, v54, v55
    v_pk_max_i16 v86, v86, 0
    v_pk_max_i16 v87, v87, 0
    v_pk_max_i16 v88, v88, 0
    v_pk_max_i16 v89, v89, 0
    v_pk_max_i16 v90, v90, 0
    v_pk_max_i16 v91, v91, 0
    v_permlane16_swap_b32 v80, v86
    v_permlane16_swap_b32 v81, v87
    v_permlane16_swap_b32 v82, v88
    v_permlane16_swap_b32 v83, v89
    v_permlane16_swap_b32 v84, v90
    v_permlane16_swap_b32 v85, v91
    s_cmp_eq_u32 s2, 1
    s_cbranch_scc1 DF_3
    buffer_store_dwordx4 v[80:83], v15, s[60:63], 0 offen offset:0 sc1
    buffer_store_dwordx4 v[84:87], v15, s[60:63], 0 offen offset:256 sc1
    buffer_store_dwordx4 v[88:91], v15, s[60:63], 0 offen offset:512 sc1
    s_branch DE_3
DF_3:
    buffer_store_dwordx4 v[80:83], v15, s[60:63], 0 offen offset:0 sc1
    buffer_store_dwordx4 v[84:87], v15, s[60:63], 0 offen offset:256 sc1
    buffer_store_dwordx4 v[88:91], v15, s[60:63], 0 offen offset:512 sc1
DE_3:
    v_pk_fma_f32 v[56:57], v[112:113], v[250:251], v[56:57] op_sel:[0,0,0] op_sel_hi:[1,0,1]
    v_pk_fma_f32 v[58:59], v[114:115], v[250:251], v[58:59] op_sel:[0,0,0] op_sel_hi:[1,0,1]
    v_pk_fma_f32 v[60:61], v[116:117], v[250:251], v[60:61] op_sel:[0,0,0] op_sel_hi:[1,0,1]
    v_pk_fma_f32 v[62:63], v[118:119], v[250:251], v[62:63] op_sel:[0,0,0] op_sel_hi:[1,0,1]
    v_pk_fma_f32 v[64:65], v[120:121], v[250:251], v[64:65] op_sel:[0,0,0] op_sel_hi:[1,0,1]
    v_pk_fma_f32 v[66:67], v[122:123], v[250:251], v[66:67] op_sel:[0,0,0] op_sel_hi:[1,0,1]
    v_pk_mul_f32 v[56:57], v[56:57], v[250:251] op_sel:[0,1] op_sel_hi:[1,1]
    v_pk_mul_f32 v[58:59], v[58:59], v[250:251] op_sel:[0,1] op_sel_hi:[1,1]
    v_pk_mul_f32 v[60:61], v[60:61], v[250:251] op_sel:[0,1] op_sel_hi:[1,1]
    v_pk_mul_f32 v[62:63], v[62:63], v[250:251] op_sel:[0,1] op_sel_hi:[1,1]
    v_pk_mul_f32 v[64:65], v[64:65], v[250:251] op_sel:[0,1] op_sel_hi:[1,1]
    v_pk_mul_f32 v[66:67], v[66:67], v[250:251] op_sel:[0,1] op_sel_hi:[1,1]
    v_cvt_pk_bf16_f32 v92, v56, v57
    v_cvt_pk_bf16_f32 v93, v58, v59
    v_cvt_pk_bf16_f32 v94, v60, v61
    v_cvt_pk_bf16_f32 v95, v62, v63
    v_cvt_pk_bf16_f32 v96, v64, v65
    v_cvt_pk_bf16_f32 v97, v66, v67
    v_pk_max_i16 v92, v92, 0
    v_pk_max_i16 v93, v93, 0
    v_pk_max_i16 v94, v94, 0
    v_pk_max_i16 v95, v95, 0
    v_pk_max_i16 v96, v96, 0
    v_pk_max_i16 v97, v97, 0
    v_pk_fma_f32 v[68:69], v[112:113], v[252:253], v[68:69] op_sel:[0,0,0] op_sel_hi:[1,0,1]
    v_pk_fma_f32 v[70:71], v[114:115], v[252:253], v[70:71] op_sel:[0,0,0] op_sel_hi:[1,0,1]
    v_pk_fma_f32 v[72:73], v[116:117], v[252:253], v[72:73] op_sel:[0,0,0] op_sel_hi:[1,0,1]
    v_pk_fma_f32 v[74:75], v[118:119], v[252:253], v[74:75] op_sel:[0,0,0] op_sel_hi:[1,0,1]
    v_pk_fma_f32 v[76:77], v[120:121], v[252:253], v[76:77] op_sel:[0,0,0] op_sel_hi:[1,0,1]
    v_pk_fma_f32 v[78:79], v[122:123], v[252:253], v[78:79] op_sel:[0,0,0] op_sel_hi:[1,0,1]
    v_pk_mul_f32 v[68:69], v[68:69], v[252:253] op_sel:[0,1] op_sel_hi:[1,1]
    v_pk_mul_f32 v[70:71], v[70:71], v[252:253] op_sel:[0,1] op_sel_hi:[1,1]
    v_pk_mul_f32 v[72:73], v[72:73], v[252:253] op_sel:[0,1] op_sel_hi:[1,1]
    v_pk_mul_f32 v[74:75], v[74:75], v[252:253] op_sel:[0,1] op_sel_hi:[1,1]
    v_pk_mul_f32 v[76:77], v[76:77], v[252:253] op_sel:[0,1] op_sel_hi:[1,1]
    v_pk_mul_f32 v[78:79], v[78:79], v[252:253] op_sel:[0,1] op_sel_hi:[1,1]
    v_cvt_pk_bf16_f32 v98, v68, v69
    v_cvt_pk_bf16_f32 v99, v70, v71
    v_cvt_pk_bf16_f32 v100, v72, v73
    v_cvt_pk_bf16_f32 v101, v74, v75
    v_cvt_pk_bf16_f32 v102, v76, v77
    v_cvt_pk_bf16_f32 v103, v78, v79
    v_pk_max_i16 v98, v98, 0
    v_pk_max_i16 v99, v99, 0
    v_pk_max_i16 v100, v100, 0
    v_pk_max_i16 v101, v101, 0
    v_pk_max_i16 v102, v102, 0
    v_pk_max_i16 v103, v103, 0
    v_permlane16_swap_b32 v92, v98
    v_permlane16_swap_b32 v93, v99
    v_permlane16_swap_b32 v94, v100
    v_permlane16_swap_b32 v95, v101
    v_permlane16_swap_b32 v96, v102
    v_permlane16_swap_b32 v97, v103
    s_cmp_eq_u32 s2, 1
    s_cbranch_scc1 DF_4
    buffer_store_dwordx4 v[92:95], v15, s[60:63], s93 offen offset:0 sc1
    buffer_store_dwordx4 v[96:99], v15, s[60:63], s93 offen offset:256 sc1
    buffer_store_dwordx4 v[100:103], v15, s[60:63], s93 offen offset:512 sc1
    s_branch DE_4
DF_4:
    buffer_store_dwordx4 v[92:95], v15, s[60:63], s93 offen offset:0 sc1
    buffer_store_dwordx4 v[96:99], v15, s[60:63], s93 offen offset:256 sc1
    buffer_store_dwordx4 v[100:103], v15, s[60:63], s93 offen offset:512 sc1
DE_4:
    s_waitcnt vmcnt(10)
    ds_read_b64_tr_b16 v[204:205], v26 offset:4096
    ds_read_b64_tr_b16 v[206:207], v26 offset:6144
    ds_read_b64_tr_b16 v[208:209], v26 offset:4104
    ds_read_b64_tr_b16 v[210:211], v26 offset:6152
    ds_read_b64_tr_b16 v[212:213], v27 offset:4096
    ds_read_b64_tr_b16 v[214:215], v27 offset:6144
    ds_read_b64_tr_b16 v[216:217], v27 offset:4104
    ds_read_b64_tr_b16 v[218:219], v27 offset:6152
    s_waitcnt vmcnt(6)
    ds_read_b64_tr_b16 v[220:221], v26 offset:8192
    ds_read_b64_tr_b16 v[222:223], v26 offset:10240
    ds_read_b64_tr_b16 v[224:225], v26 offset:8200
    ds_read_b64_tr_b16 v[226:227], v26 offset:10248
    ds_read_b64_tr_b16 v[228:229], v27 offset:8192
    ds_read_b64_tr_b16 v[230:231], v27 offset:10240
    ds_read_b64_tr_b16 v[232:233], v27 offset:8200
    ds_read_b64_tr_b16 v[234:235], v27 offset:10248
    s_waitcnt vmcnt(0)
    s_barrier
    s_cmp_lg_u32 s64, 0
    s_cbranch_scc1 PF_2
    v_mov_b32 v12, 3
    s_mov_b64 exec, 1
    s_cmp_eq_u32 s2, 1
    s_cbranch_scc1 FF_2
    buffer_store_dword v12, off, s[60:63], s92 sc1
    s_branch FE_2
FF_2:
    buffer_store_dword v12, off, s[60:63], s92
FE_2:
    s_mov_b64 exec, -1
    s_branch NOPOST_2
PF_2:
    s_cmp_eq_u32 s2, 1
    s_cbranch_scc1 NOPOST_2
    s_mov_b32 m0, 160384
    s_mul_i32 s84, s66, 3
    s_add_u32 s84, s84, s64
    s_lshl_b32 s84, s84, 11
    s_mul_i32 s85, s67, 3
    s_add_u32 s84, s84, s85
    s_sub_u32 s84, s84, 2048
    buffer_load_dwordx4 v1, s[60:63], s84 offen sc1 lds
    s_add_u32 s84, s84, 1024
    buffer_load_dwordx4 v1, s[60:63], s84 offen sc1 lds
    s_add_u32 s84, s84, 48128
    buffer_load_dwordx4 v1, s[60:63], s84 offen sc1 lds
    s_add_u32 s84, s84, 1024
    buffer_load_dwordx4 v1, s[60:63], s84 offen sc1 lds
    s_add_u32 s84, s84, 48128
    buffer_load_dwordx4 v1, s[60:63], s84 offen sc1 lds
    s_add_u32 s84, s84, 1024
    buffer_load_dwordx4 v1, s[60:63], s84 offen sc1 lds
    s_add_u32 s84, s84, 48128
    buffer_load_dwordx4 v1, s[60:63], s84 offen sc1 lds
    s_add_u32 s84, s84, 1024
    buffer_load_dwordx4 v1, s[60:63], s84 offen sc1 lds
NOPOST_2:
    s_mov_b32 s83, 0x40000
POLL_2:
    buffer_load_dwordx2 v[10:11], v13, s[60:63], s82 offen sc1
    s_waitcnt vmcnt(0)
    v_cmp_gt_u32 vcc, 3, v10
    s_nop 4
    s_cbranch_vccz DONE_2
    s_sub_u32 s83, s83, 1
    s_cmp_lg_u32 s83, 0
    s_cbranch_scc1 POLL_2
DONE_2:
    buffer_load_dwordx4 a[108:111], v14, s[60:63], s77 offen offset:0 sc1
    buffer_load_dwordx4 a[112:115], v14, s[60:63], s77 offen offset:1024 sc1
    s_cmp_ge_u32 s3, 3
    s_cselect_b32 s81, 11264, 0
    s_sub_u32 s81, s77, s81
    s_add_u32 s81, s81, 2048
    buffer_load_dwordx4 a[116:119], v14, s[60:63], s81 offen offset:0 sc1
    s_cmp_ge_u32 s3, 3
    s_cselect_b32 s81, 11264, 0
    s_sub_u32 s81, s77, s81
    s_add_u32 s81, s81, 3072
    buffer_load_dwordx4 a[120:123], v14, s[60:63], s81 offen offset:0 sc1
    s_cmp_ge_u32 s3, 3
    s_cselect_b32 s81, 11264, 0
    s_sub_u32 s81, s77, s81
    s_add_u32 s81, s81, 4096
    buffer_load_dwordx4 a[124:127], v14, s[60:63], s81 offen offset:0 sc1
    s_cmp_ge_u32 s3, 2
    s_cselect_b32 s81, 11264, 0
    s_sub_u32 s81, s77, s81
    s_add_u32 s81, s81, 5120
    buffer_load_dwordx4 a[128:131], v14, s[60:63], s81 offen offset:0 sc1
    s_cmp_ge_u32 s3, 2
    s_cselect_b32 s81, 11264, 0
    s_sub_u32 s81, s77, s81
    s_add_u32 s81, s81, 6144
    buffer_load_dwordx4 a[132:135], v14, s[60:63], s81 offen offset:0 sc1
    s_cmp_ge_u32 s3, 2
    s_cselect_b32 s81, 11264, 0
    s_sub_u32 s81, s77, s81
    s_add_u32 s81, s81, 7168
    buffer_load_dwordx4 a[136:139], v14, s[60:63], s81 offen offset:0 sc1
    s_cmp_ge_u32 s3, 1
    s_cselect_b32 s81, 11264, 0
    s_sub_u32 s81, s77, s81
    s_add_u32 s81, s81, 8192
    buffer_load_dwordx4 a[140:143], v14, s[60:63], s81 offen offset:0 sc1
    s_cmp_ge_u32 s3, 1
    s_cselect_b32 s81, 11264, 0
    s_sub_u32 s81, s77, s81
    s_add_u32 s81, s81, 9216
    buffer_load_dwordx4 a[144:147], v14, s[60:63], s81 offen offset:0 sc1
    s_cmp_ge_u32 s3, 1
    s_cselect_b32 s81, 11264, 0
    s_sub_u32 s81, s77, s81
    s_add_u32 s81, s81, 10240
    buffer_load_dwordx4 a[148:151], v14, s[60:63], s81 offen offset:0 sc1
    buffer_load_dwordx4 a[152:155], v14, s[60:63], s78 offen offset:0 sc1
    s_add_u32 s84, s64, 1
    s_and_b32 s84, s84, 3
    s_mul_i32 s84, s84, 12288
    v_add_u32 v96, s84, v1
    s_add_u32 s84, s64, 2
    s_and_b32 s84, s84, 3
    s_mul_i32 s84, s84, 12288
    v_add_u32 v97, s84, v1
    s_add_u32 s84, s64, 3
    s_and_b32 s84, s84, 3
    s_mul_i32 s84, s84, 12288
    v_add_u32 v98, s84, v1
    s_mul_i32 s84, s64, 12288
    v_add_u32 v99, s84, v1
    v_lshlrev_b32 v32, 16, v238
    v_and_b32 v33, 0xffff0000, v238
    v_lshlrev_b32 v34, 16, v239
    v_and_b32 v35, 0xffff0000, v239
    v_lshlrev_b32 v36, 16, v240
    v_and_b32 v37, 0xffff0000, v240
    v_lshlrev_b32 v38, 16, v241
    v_and_b32 v39, 0xffff0000, v241
    v_lshlrev_b32 v40, 16, v242
    v_and_b32 v41, 0xffff0000, v242
    v_lshlrev_b32 v42, 16, v243
    v_and_b32 v43, 0xffff0000, v243
    v_lshlrev_b32 v44, 16, v244
    v_and_b32 v45, 0xffff0000, v244
    v_lshlrev_b32 v46, 16, v245
    v_and_b32 v47, 0xffff0000, v245
    s_waitcnt vmcnt(11)
    v_mfma_f32_16x16x32_bf16 v[48:51], a[0:3], a[108:111], 0
    v_mfma_f32_16x16x32_bf16 v[52:55], a[4:7], a[108:111], 0
    v_mfma_f32_16x16x32_bf16 v[56:59], a[8:11], a[108:111], 0
    v_mfma_f32_16x16x32_bf16 v[60:63], a[12:15], a[108:111], 0
    buffer_load_dwordx4 a[156:159], v14, s[60:63], s78 offen offset:1024 sc1
    s_waitcnt vmcnt(11)
    v_mfma_f32_16x16x32_bf16 v[48:51], a[16:19], a[112:115], v[48:51]
    v_mfma_f32_16x16x32_bf16 v[52:55], a[20:23], a[112:115], v[52:55]
    v_mfma_f32_16x16x32_bf16 v[56:59], a[24:27], a[112:115], v[56:59]
    v_mfma_f32_16x16x32_bf16 v[60:63], a[28:31], a[112:115], v[60:63]
    s_cmp_ge_u32 s3, 3
    s_cselect_b32 s81, 11264, 0
    s_sub_u32 s81, s78, s81
    s_add_u32 s81, s81, 2048
    buffer_load_dwordx4 a[160:163], v14, s[60:63], s81 offen offset:0 sc1
    s_waitcnt vmcnt(11)
    v_mfma_f32_16x16x32_bf16 v[48:51], a[32:35], a[116:119], v[48:51]
    v_mfma_f32_16x16x32_bf16 v[52:55], a[36:39], a[116:119], v[52:55]
    v_mfma_f32_16x16x32_bf16 v[56:59], a[40:43], a[116:119], v[56:59]
    v_mfma_f32_16x16x32_bf16 v[60:63], a[44:47], a[116:119], v[60:63]
    s_cmp_ge_u32 s3, 3
    s_cselect_b32 s81, 11264, 0
    s_sub_u32 s81, s78, s81
    s_add_u32 s81, s81, 3072
    buffer_load_dwordx4 a[164:167], v14, s[60:63], s81 offen offset:0 sc1
    s_waitcnt vmcnt(11)
    v_mfma_f32_16x16x32_bf16 v[48:51], a[48:51], a[120:123], v[48:51]
    v_mfma_f32_16x16x32_bf16 v[52:55], a[52:55], a[120:123], v[52:55]
    v_mfma_f32_16x16x32_bf16 v[56:59], a[56:59], a[120:123], v[56:59]
    v_mfma_f32_16x16x32_bf16 v[60:63], a[60:63], a[120:123], v[60:63]
    s_cmp_ge_u32 s3, 3
    s_cselect_b32 s81, 11264, 0
    s_sub_u32 s81, s78, s81
    s_add_u32 s81, s81, 4096
    buffer_load_dwordx4 a[168:171], v14, s[60:63], s81 offen offset:0 sc1
    s_waitcnt vmcnt(11)
    v_mfma_f32_16x16x32_bf16 v[48:51], v[124:127], a[124:127], v[48:51]
    v_mfma_f32_16x16x32_bf16 v[52:55], v[128:131], a[124:127], v[52:55]
    v_mfma_f32_16x16x32_bf16 v[56:59], v[132:135], a[124:127], v[56:59]
    v_mfma_f32_16x16x32_bf16 v[60:63], v[136:139], a[124:127], v[60:63]
    s_cmp_ge_u32 s3, 2
    s_cselect_b32 s81, 11264, 0
    s_sub_u32 s81, s78, s81
    s_add_u32 s81, s81, 5120
    buffer_load_dwordx4 a[172:175], v14, s[60:63], s81 offen offset:0 sc1
    s_waitcnt vmcnt(11)
    v_mfma_f32_16x16x32_bf16 v[48:51], v[140:143], a[128:131], v[48:51]
    v_mfma_f32_16x16x32_bf16 v[52:55], v[144:147], a[128:131], v[52:55]
    v_mfma_f32_16x16x32_bf16 v[56:59], v[148:151], a[128:131], v[56:59]
    v_mfma_f32_16x16x32_bf16 v[60:63], v[152:155], a[128:131], v[60:63]
    s_cmp_ge_u32 s3, 2
    s_cselect_b32 s81, 11264, 0
    s_sub_u32 s81, s78, s81
    s_add_u32 s81, s81, 6144
    buffer_load_dwordx4 a[176:179], v14, s[60:63], s81 offen offset:0 sc1
    s_waitcnt vmcnt(11)
    v_mfma_f32_16x16x32_bf16 v[48:51], v[156:159], a[132:135], v[48:51]
    v_mfma_f32_16x16x32_bf16 v[52:55], v[160:163], a[132:135], v[52:55]
    v_mfma_f32_16x16x32_bf16 v[56:59], v[164:167], a[132:135], v[56:59]
    v_mfma_f32_16x16x32_bf16 v[60:63], v[168:171], a[132:135], v[60:63]
    s_cmp_ge_u32 s3, 2
    s_cselect_b32 s81, 11264, 0
    s_sub_u32 s81, s78, s81
    s_add_u32 s81, s81, 7168
    buffer_load_dwordx4 a[180:183], v14, s[60:63], s81 offen offset:0 sc1
    s_waitcnt vmcnt(11)
    v_mfma_f32_16x16x32_bf16 v[48:51], v[172:175], a[136:139], v[48:51]
    v_mfma_f32_16x16x32_bf16 v[52:55], v[176:179], a[136:139], v[52:55]
    s_waitcnt lgkmcnt(15)
    v_mfma_f32_16x16x32_bf16 v[56:59], v[180:183], a[136:139], v[56:59]
    v_mfma_f32_16x16x32_bf16 v[60:63], v[184:187], a[136:139], v[60:63]
    s_cmp_ge_u32 s3, 1
    s_cselect_b32 s81, 11264, 0
    s_sub_u32 s81, s78, s81
    s_add_u32 s81, s81, 8192
    buffer_load_dwordx4 a[184:187], v14, s[60:63], s81 offen offset:0 sc1
    s_waitcnt vmcnt(11)
    v_mfma_f32_16x16x32_bf16 v[48:51], v[188:191], a[140:143], v[48:51]
    v_mfma_f32_16x16x32_bf16 v[52:55], v[192:195], a[140:143], v[52:55]
    v_mfma_f32_16x16x32_bf16 v[56:59], v[196:199], a[140:143], v[56:59]
    v_mfma_f32_16x16x32_bf16 v[60:63], v[200:203], a[140:143], v[60:63]
    s_cmp_ge_u32 s3, 1
    s_cselect_b32 s81, 11264, 0
    s_sub_u32 s81, s78, s81
    s_add_u32 s81, s81, 9216
    buffer_load_dwordx4 a[188:191], v14, s[60:63], s81 offen offset:0 sc1
    s_waitcnt vmcnt(11)
    s_waitcnt lgkmcnt(14)
    v_mfma_f32_16x16x32_bf16 v[48:51], v[204:207], a[144:147], v[48:51]
    s_waitcnt lgkmcnt(12)
    v_mfma_f32_16x16x32_bf16 v[52:55], v[208:211], a[144:147], v[52:55]
    s_waitcnt lgkmcnt(10)
    v_mfma_f32_16x16x32_bf16 v[56:59], v[212:215], a[144:147], v[56:59]
    s_waitcnt lgkmcnt(8)
    v_mfma_f32_16x16x32_bf16 v[60:63], v[216:219], a[144:147], v[60:63]
    s_cmp_ge_u32 s3, 1
    s_cselect_b32 s81, 11264, 0
    s_sub_u32 s81, s78, s81
    s_add_u32 s81, s81, 10240
    buffer_load_dwordx4 a[192:195], v14, s[60:63], s81 offen offset:0 sc1
    s_waitcnt vmcnt(11)
    s_waitcnt lgkmcnt(6)
    v_mfma_f32_16x16x32_bf16 v[48:51], v[220:223], a[148:151], v[48:51]
    s_waitcnt lgkmcnt(4)
    v_mfma_f32_16x16x32_bf16 v[52:55], v[224:227], a[148:151], v[52:55]
    s_waitcnt lgkmcnt(2)
    v_mfma_f32_16x16x32_bf16 v[56:59], v[228:231], a[148:151], v[56:59]
    s_waitcnt lgkmcnt(0)
    v_mfma_f32_16x16x32_bf16 v[60:63], v[232:235], a[148:151], v[60:63]
    buffer_load_dwordx4 a[196:199], v14, s[60:63], s79 offen offset:0 sc1
    s_waitcnt vmcnt(11)
    v_mfma_f32_16x16x32_bf16 v[64:67], a[0:3], a[152:155], 0
    v_mfma_f32_16x16x32_bf16 v[68:71], a[4:7], a[152:155], 0
    v_mfma_f32_16x16x32_bf16 v[72:75], a[8:11], a[152:155], 0
    v_mfma_f32_16x16x32_bf16 v[76:79], a[12:15], a[152:155], 0
    buffer_load_dwordx4 a[200:203], v14, s[60:63], s79 offen offset:1024 sc1
    s_waitcnt vmcnt(11)
    v_mfma_f32_16x16x32_bf16 v[64:67], a[16:19], a[156:159], v[64:67]
    ds_write_b128 v96, v[48:51] offset:0
    v_mfma_f32_16x16x32_bf16 v[68:71], a[20:23], a[156:159], v[68:71]
    ds_write_b128 v96, v[52:55] offset:1024
    v_mfma_f32_16x16x32_bf16 v[72:75], a[24:27], a[156:159], v[72:75]
    ds_write_b128 v96, v[56:59] offset:2048
    v_mfma_f32_16x16x32_bf16 v[76:79], a[28:31], a[156:159], v[76:79]
    ds_write_b128 v96, v[60:63] offset:3072
    s_cmp_ge_u32 s3, 3
    s_cselect_b32 s81, 11264, 0
    s_sub_u32 s81, s79, s81
    s_add_u32 s81, s81, 2048
    buffer_load_dwordx4 a[204:207], v14, s[60:63], s81 offen offset:0 sc1
    s_waitcnt vmcnt(11)
    v_mfma_f32_16x16x32_bf16 v[64:67], a[32:35], a[160:163], v[64:67]
    v_mfma_f32_16x16x32_bf16 v[68:71], a[36:39], a[160:163], v[68:71]
    v_mfma_f32_16x16x32_bf16 v[72:75], a[40:43], a[160:163], v[72:75]
    v_mfma_f32_16x16x32_bf16 v[76:79], a[44:47], a[160:163], v[76:79]
    s_cmp_ge_u32 s3, 3
    s_cselect_b32 s81, 11264, 0
    s_sub_u32 s81, s79, s81
    s_add_u32 s81, s81, 3072
    buffer_load_dwordx4 a[208:211], v14, s[60:63], s81 offen offset:0 sc1
    s_waitcnt vmcnt(11)
    v_mfma_f32_16x16x32_bf16 v[64:67], a[48:51], a[164:167], v[64:67]
    v_mfma_f32_16x16x32_bf16 v[68:71], a[52:55], a[164:167], v[68:71]
    v_mfma_f32_16x16x32_bf16 v[72:75], a[56:59], a[164:167], v[72:75]
    v_mfma_f32_16x16x32_bf16 v[76:79], a[60:63], a[164:167], v[76:79]
    s_cmp_ge_u32 s3, 3
    s_cselect_b32 s81, 11264, 0
    s_sub_u32 s81, s79, s81
    s_add_u32 s81, s81, 4096
    buffer_load_dwordx4 a[212:215], v14, s[60:63], s81 offen offset:0 sc1
    s_waitcnt vmcnt(11)
    v_mfma_f32_16x16x32_bf16 v[64:67], v[124:127], a[168:171], v[64:67]
    v_mfma_f32_16x16x32_bf16 v[68:71], v[128:131], a[168:171], v[68:71]
    v_mfma_f32_16x16x32_bf16 v[72:75], v[132:135], a[168:171], v[72:75]
    v_mfma_f32_16x16x32_bf16 v[76:79], v[136:139], a[168:171], v[76:79]
    s_cmp_ge_u32 s3, 2
    s_cselect_b32 s81, 11264, 0
    s_sub_u32 s81, s79, s81
    s_add_u32 s81, s81, 5120
    buffer_load_dwordx4 a[216:219], v14, s[60:63], s81 offen offset:0 sc1
    s_waitcnt vmcnt(11)
    v_mfma_f32_16x16x32_bf16 v[64:67], v[140:143], a[172:175], v[64:67]
    v_mfma_f32_16x16x32_bf16 v[68:71], v[144:147], a[172:175], v[68:71]
    v_mfma_f32_16x16x32_bf16 v[72:75], v[148:151], a[172:175], v[72:75]
    v_mfma_f32_16x16x32_bf16 v[76:79], v[152:155], a[172:175], v[76:79]
    s_cmp_ge_u32 s3, 2
    s_cselect_b32 s81, 11264, 0
    s_sub_u32 s81, s79, s81
    s_add_u32 s81, s81, 6144
    buffer_load_dwordx4 a[220:223], v14, s[60:63], s81 offen offset:0 sc1
    s_waitcnt vmcnt(11)
    v_mfma_f32_16x16x32_bf16 v[64:67], v[156:159], a[176:179], v[64:67]
    v_mfma_f32_16x16x32_bf16 v[68:71], v[160:163], a[176:179], v[68:71]
    v_mfma_f32_16x16x32_bf16 v[72:75], v[164:167], a[176:179], v[72:75]
    v_mfma_f32_16x16x32_bf16 v[76:79], v[168:171], a[176:179], v[76:79]
    s_cmp_ge_u32 s3, 2
    s_cselect_b32 s81, 11264, 0
    s_sub_u32 s81, s79, s81
    s_add_u32 s81, s81, 7168
    buffer_load_dwordx4 a[224:227], v14, s[60:63], s81 offen offset:0 sc1
    s_waitcnt vmcnt(11)
    v_mfma_f32_16x16x32_bf16 v[64:67], v[172:175], a[180:183], v[64:67]
    v_mfma_f32_16x16x32_bf16 v[68:71], v[176:179], a[180:183], v[68:71]
    v_mfma_f32_16x16x32_bf16 v[72:75], v[180:183], a[180:183], v[72:75]
    v_mfma_f32_16x16x32_bf16 v[76:79], v[184:187], a[180:183], v[76:79]
    s_cmp_ge_u32 s3, 1
    s_cselect_b32 s81, 11264, 0
    s_sub_u32 s81, s79, s81
    s_add_u32 s81, s81, 8192
    buffer_load_dwordx4 a[228:231], v14, s[60:63], s81 offen offset:0 sc1
    s_waitcnt vmcnt(11)
    v_mfma_f32_16x16x32_bf16 v[64:67], v[188:191], a[184:187], v[64:67]
    v_mfma_f32_16x16x32_bf16 v[68:71], v[192:195], a[184:187], v[68:71]
    v_mfma_f32_16x16x32_bf16 v[72:75], v[196:199], a[184:187], v[72:75]
    v_mfma_f32_16x16x32_bf16 v[76:79], v[200:203], a[184:187], v[76:79]
    s_cmp_ge_u32 s3, 1
    s_cselect_b32 s81, 11264, 0
    s_sub_u32 s81, s79, s81
    s_add_u32 s81, s81, 9216
    buffer_load_dwordx4 a[232:235], v14, s[60:63], s81 offen offset:0 sc1
    s_waitcnt vmcnt(11)
    v_mfma_f32_16x16x32_bf16 v[64:67], v[204:207], a[188:191], v[64:67]
    v_mfma_f32_16x16x32_bf16 v[68:71], v[208:211], a[188:191], v[68:71]
    v_mfma_f32_16x16x32_bf16 v[72:75], v[212:215], a[188:191], v[72:75]
    v_mfma_f32_16x16x32_bf16 v[76:79], v[216:219], a[188:191], v[76:79]
    s_cmp_ge_u32 s3, 1
    s_cselect_b32 s81, 11264, 0
    s_sub_u32 s81, s79, s81
    s_add_u32 s81, s81, 10240
    buffer_load_dwordx4 a[236:239], v14, s[60:63], s81 offen offset:0 sc1
    s_waitcnt vmcnt(11)
    v_mfma_f32_16x16x32_bf16 v[64:67], v[220:223], a[192:195], v[64:67]
    v_mfma_f32_16x16x32_bf16 v[68:71], v[224:227], a[192:195], v[68:71]
    v_mfma_f32_16x16x32_bf16 v[72:75], v[228:231], a[192:195], v[72:75]
    v_mfma_f32_16x16x32_bf16 v[76:79], v[232:235], a[192:195], v[76:79]
    buffer_load_dwordx4 a[64:67], v14, s[60:63], s76 offen offset:0 sc1
    s_waitcnt vmcnt(11)
    v_mfma_f32_16x16x32_bf16 v[80:83], a[0:3], a[196:199], 0
    v_mfma_f32_16x16x32_bf16 v[84:87], a[4:7], a[196:199], 0
    v_mfma_f32_16x16x32_bf16 v[88:91], a[8:11], a[196:199], 0
    v_mfma_f32_16x16x32_bf16 v[92:95], a[12:15], a[196:199], 0
    buffer_load_dwordx4 a[68:71], v14, s[60:63], s76 offen offset:1024 sc1
    s_waitcnt vmcnt(11)
    v_mfma_f32_16x16x32_bf16 v[80:83], a[16:19], a[200:203], v[80:83]
    ds_write_b128 v97, v[64:67] offset:4096
    v_mfma_f32_16x16x32_bf16 v[84:87], a[20:23], a[200:203], v[84:87]
    ds_write_b128 v97, v[68:71] offset:5120
    v_mfma_f32_16x16x32_bf16 v[88:91], a[24:27], a[200:203], v[88:91]
    ds_write_b128 v97, v[72:75] offset:6144
    v_mfma_f32_16x16x32_bf16 v[92:95], a[28:31], a[200:203], v[92:95]
    ds_write_b128 v97, v[76:79] offset:7168
    s_cmp_ge_u32 s3, 3
    s_cselect_b32 s81, 11264, 0
    s_sub_u32 s81, s76, s81
    s_add_u32 s81, s81, 2048
    buffer_load_dwordx4 a[72:75], v14, s[60:63], s81 offen offset:0 sc1
    s_waitcnt vmcnt(11)
    v_mfma_f32_16x16x32_bf16 v[80:83], a[32:35], a[204:207], v[80:83]
    v_mfma_f32_16x16x32_bf16 v[84:87], a[36:39], a[204:207], v[84:87]
    v_mfma_f32_16x16x32_bf16 v[88:91], a[40:43], a[204:207], v[88:91]
    v_mfma_f32_16x16x32_bf16 v[92:95], a[44:47], a[204:207], v[92:95]
    s_cmp_ge_u32 s3, 3
    s_cselect_b32 s81, 11264, 0
    s_sub_u32 s81, s76, s81
    s_add_u32 s81, s81, 3072
    buffer_load_dwordx4 a[76:79], v14, s[60:63], s81 offen offset:0 sc1
    s_waitcnt vmcnt(11)
    v_mfma_f32_16x16x32_bf16 v[80:83], a[48:51], a[208:211], v[80:83]
    v_mfma_f32_16x16x32_bf16 v[84:87], a[52:55], a[208:211], v[84:87]
    v_mfma_f32_16x16x32_bf16 v[88:91], a[56:59], a[208:211], v[88:91]
    v_mfma_f32_16x16x32_bf16 v[92:95], a[60:63], a[208:211], v[92:95]
    s_cmp_ge_u32 s3, 3
    s_cselect_b32 s81, 11264, 0
    s_sub_u32 s81, s76, s81
    s_add_u32 s81, s81, 4096
    buffer_load_dwordx4 a[80:83], v14, s[60:63], s81 offen offset:0 sc1
    s_waitcnt vmcnt(11)
    v_mfma_f32_16x16x32_bf16 v[80:83], v[124:127], a[212:215], v[80:83]
    v_mfma_f32_16x16x32_bf16 v[84:87], v[128:131], a[212:215], v[84:87]
    v_mfma_f32_16x16x32_bf16 v[88:91], v[132:135], a[212:215], v[88:91]
    v_mfma_f32_16x16x32_bf16 v[92:95], v[136:139], a[212:215], v[92:95]
    s_cmp_ge_u32 s3, 2
    s_cselect_b32 s81, 11264, 0
    s_sub_u32 s81, s76, s81
    s_add_u32 s81, s81, 5120
    buffer_load_dwordx4 a[84:87], v14, s[60:63], s81 offen offset:0 sc1
    s_waitcnt vmcnt(11)
    v_mfma_f32_16x16x32_bf16 v[80:83], v[140:143], a[216:219], v[80:83]
    v_mfma_f32_16x16x32_bf16 v[84:87], v[144:147], a[216:219], v[84:87]
    v_mfma_f32_16x16x32_bf16 v[88:91], v[148:151], a[216:219], v[88:91]
    v_mfma_f32_16x16x32_bf16 v[92:95], v[152:155], a[216:219], v[92:95]
    s_cmp_ge_u32 s3, 2
    s_cselect_b32 s81, 11264, 0
    s_sub_u32 s81, s76, s81
    s_add_u32 s81, s81, 6144
    buffer_load_dwordx4 a[88:91], v14, s[60:63], s81 offen offset:0 sc1
    s_waitcnt vmcnt(11)
    v_mfma_f32_16x16x32_bf16 v[80:83], v[156:159], a[220:223], v[80:83]
    v_mfma_f32_16x16x32_bf16 v[84:87], v[160:163], a[220:223], v[84:87]
    v_mfma_f32_16x16x32_bf16 v[88:91], v[164:167], a[220:223], v[88:91]
    v_mfma_f32_16x16x32_bf16 v[92:95], v[168:171], a[220:223], v[92:95]
    s_cmp_ge_u32 s3, 2
    s_cselect_b32 s81, 11264, 0
    s_sub_u32 s81, s76, s81
    s_add_u32 s81, s81, 7168
    buffer_load_dwordx4 a[92:95], v14, s[60:63], s81 offen offset:0 sc1
    s_waitcnt vmcnt(11)
    v_mfma_f32_16x16x32_bf16 v[80:83], v[172:175], a[224:227], v[80:83]
    v_mfma_f32_16x16x32_bf16 v[84:87], v[176:179], a[224:227], v[84:87]
    v_mfma_f32_16x16x32_bf16 v[88:91], v[180:183], a[224:227], v[88:91]
    v_mfma_f32_16x16x32_bf16 v[92:95], v[184:187], a[224:227], v[92:95]
    s_cmp_ge_u32 s3, 1
    s_cselect_b32 s81, 11264, 0
    s_sub_u32 s81, s76, s81
    s_add_u32 s81, s81, 8192
    buffer_load_dwordx4 a[96:99], v14, s[60:63], s81 offen offset:0 sc1
    s_waitcnt vmcnt(11)
    v_mfma_f32_16x16x32_bf16 v[80:83], v[188:191], a[228:231], v[80:83]
    v_mfma_f32_16x16x32_bf16 v[84:87], v[192:195], a[228:231], v[84:87]
    v_mfma_f32_16x16x32_bf16 v[88:91], v[196:199], a[228:231], v[88:91]
    v_mfma_f32_16x16x32_bf16 v[92:95], v[200:203], a[228:231], v[92:95]
    s_cmp_ge_u32 s3, 1
    s_cselect_b32 s81, 11264, 0
    s_sub_u32 s81, s76, s81
    s_add_u32 s81, s81, 9216
    buffer_load_dwordx4 a[100:103], v14, s[60:63], s81 offen offset:0 sc1
    s_waitcnt vmcnt(11)
    v_mfma_f32_16x16x32_bf16 v[80:83], v[204:207], a[232:235], v[80:83]
    v_mfma_f32_16x16x32_bf16 v[84:87], v[208:211], a[232:235], v[84:87]
    v_mfma_f32_16x16x32_bf16 v[88:91], v[212:215], a[232:235], v[88:91]
    v_mfma_f32_16x16x32_bf16 v[92:95], v[216:219], a[232:235], v[92:95]
    s_cmp_ge_u32 s3, 1
    s_cselect_b32 s81, 11264, 0
    s_sub_u32 s81, s76, s81
    s_add_u32 s81, s81, 10240
    buffer_load_dwordx4 a[104:107], v14, s[60:63], s81 offen offset:0 sc1
    s_waitcnt vmcnt(11)
    v_mfma_f32_16x16x32_bf16 v[80:83], v[220:223], a[236:239], v[80:83]
    v_mfma_f32_16x16x32_bf16 v[84:87], v[224:227], a[236:239], v[84:87]
    v_mfma_f32_16x16x32_bf16 v[88:91], v[228:231], a[236:239], v[88:91]
    v_mfma_f32_16x16x32_bf16 v[92:95], v[232:235], a[236:239], v[92:95]
    s_waitcnt vmcnt(10)
    v_mfma_f32_16x16x32_bf16 v[32:35], a[0:3], a[64:67], v[32:35]
    v_mfma_f32_16x16x32_bf16 v[36:39], a[4:7], a[64:67], v[36:39]
    v_mfma_f32_16x16x32_bf16 v[40:43], a[8:11], a[64:67], v[40:43]
    v_mfma_f32_16x16x32_bf16 v[44:47], a[12:15], a[64:67], v[44:47]
    s_waitcnt vmcnt(9)
    v_mfma_f32_16x16x32_bf16 v[32:35], a[16:19], a[68:71], v[32:35]
    ds_write_b128 v98, v[80:83] offset:8192
    v_mfma_f32_16x16x32_bf16 v[36:39], a[20:23], a[68:71], v[36:39]
    ds_write_b128 v98, v[84:87] offset:9216
    v_mfma_f32_16x16x32_bf16 v[40:43], a[24:27], a[68:71], v[40:43]
    ds_write_b128 v98, v[88:91] offset:10240
    v_mfma_f32_16x16x32_bf16 v[44:47], a[28:31], a[68:71], v[44:47]
    ds_write_b128 v98, v[92:95] offset:11264
    s_waitcnt vmcnt(8)
    v_mfma_f32_16x16x32_bf16 v[32:35], a[32:35], a[72:75], v[32:35]
    v_mfma_f32_16x16x32_bf16 v[36:39], a[36:39], a[72:75], v[36:39]
    v_mfma_f32_16x16x32_bf16 v[40:43], a[40:43], a[72:75], v[40:43]
    v_mfma_f32_16x16x32_bf16 v[44:47], a[44:47], a[72:75], v[44:47]
    s_waitcnt vmcnt(7)
    v_mfma_f32_16x16x32_bf16 v[32:35], a[48:51], a[76:79], v[32:35]
    v_mfma_f32_16x16x32_bf16 v[36:39], a[52:55], a[76:79], v[36:39]
    v_mfma_f32_16x16x32_bf16 v[40:43], a[56:59], a[76:79], v[40:43]
    v_mfma_f32_16x16x32_bf16 v[44:47], a[60:63], a[76:79], v[44:47]
    s_waitcnt vmcnt(6)
    v_mfma_f32_16x16x32_bf16 v[32:35], v[124:127], a[80:83], v[32:35]
    v_mfma_f32_16x16x32_bf16 v[36:39], v[128:131], a[80:83], v[36:39]
    v_mfma_f32_16x16x32_bf16 v[40:43], v[132:135], a[80:83], v[40:43]
    v_mfma_f32_16x16x32_bf16 v[44:47], v[136:139], a[80:83], v[44:47]
    s_waitcnt vmcnt(5)
    v_mfma_f32_16x16x32_bf16 v[32:35], v[140:143], a[84:87], v[32:35]
    v_mfma_f32_16x16x32_bf16 v[36:39], v[144:147], a[84:87], v[36:39]
    v_mfma_f32_16x16x32_bf16 v[40:43], v[148:151], a[84:87], v[40:43]
    v_mfma_f32_16x16x32_bf16 v[44:47], v[152:155], a[84:87], v[44:47]
    s_waitcnt vmcnt(4)
    v_mfma_f32_16x16x32_bf16 v[32:35], v[156:159], a[88:91], v[32:35]
    v_mfma_f32_16x16x32_bf16 v[36:39], v[160:163], a[88:91], v[36:39]
    v_mfma_f32_16x16x32_bf16 v[40:43], v[164:167], a[88:91], v[40:43]
    v_mfma_f32_16x16x32_bf16 v[44:47], v[168:171], a[88:91], v[44:47]
    s_waitcnt vmcnt(3)
    v_mfma_f32_16x16x32_bf16 v[32:35], v[172:175], a[92:95], v[32:35]
    v_mfma_f32_16x16x32_bf16 v[36:39], v[176:179], a[92:95], v[36:39]
    v_mfma_f32_16x16x32_bf16 v[40:43], v[180:183], a[92:95], v[40:43]
    v_mfma_f32_16x16x32_bf16 v[44:47], v[184:187], a[92:95], v[44:47]
    s_waitcnt vmcnt(2)
    v_mfma_f32_16x16x32_bf16 v[32:35], v[188:191], a[96:99], v[32:35]
    v_mfma_f32_16x16x32_bf16 v[36:39], v[192:195], a[96:99], v[36:39]
    v_mfma_f32_16x16x32_bf16 v[40:43], v[196:199], a[96:99], v[40:43]
    v_mfma_f32_16x16x32_bf16 v[44:47], v[200:203], a[96:99], v[44:47]
    s_waitcnt vmcnt(1)
    v_mfma_f32_16x16x32_bf16 v[32:35], v[204:207], a[100:103], v[32:35]
    v_mfma_f32_16x16x32_bf16 v[36:39], v[208:211], a[100:103], v[36:39]
    v_mfma_f32_16x16x32_bf16 v[40:43], v[212:215], a[100:103], v[40:43]
    v_mfma_f32_16x16x32_bf16 v[44:47], v[216:219], a[100:103], v[44:47]
    s_waitcnt vmcnt(0)
    v_mfma_f32_16x16x32_bf16 v[32:35], v[220:223], a[104:107], v[32:35]
    v_mfma_f32_16x16x32_bf16 v[36:39], v[224:227], a[104:107], v[36:39]
    v_mfma_f32_16x16x32_bf16 v[40:43], v[228:231], a[104:107], v[40:43]
    v_mfma_f32_16x16x32_bf16 v[44:47], v[232:235], a[104:107], v[44:47]
    s_waitcnt lgkmcnt(0)
    s_barrier
    ds_read_b128 v[124:127], v99 offset:0
    ds_read_b128 v[128:131], v99 offset:1024
    ds_read_b128 v[132:135], v99 offset:2048
    ds_read_b128 v[136:139], v99 offset:3072
    ds_read_b128 v[140:143], v99 offset:4096
    ds_read_b128 v[144:147], v99 offset:5120
    ds_read_b128 v[148:151], v99 offset:6144
    ds_read_b128 v[152:155], v99 offset:7168
    ds_read_b128 v[156:159], v99 offset:8192
    ds_read_b128 v[160:163], v99 offset:9216
    ds_read_b128 v[164:167], v99 offset:10240
    ds_read_b128 v[168:171], v99 offset:11264
    s_waitcnt lgkmcnt(11)
    v_pk_add_f32 v[32:33], v[32:33], v[124:125]
    v_pk_add_f32 v[34:35], v[34:35], v[126:127]
    s_waitcnt lgkmcnt(10)
    v_pk_add_f32 v[36:37], v[36:37], v[128:129]
    v_pk_add_f32 v[38:39], v[38:39], v[130:131]
    s_waitcnt lgkmcnt(9)
    v_pk_add_f32 v[40:41], v[40:41], v[132:133]
    v_pk_add_f32 v[42:43], v[42:43], v[134:135]
    s_waitcnt lgkmcnt(8)
    v_pk_add_f32 v[44:45], v[44:45], v[136:137]
    v_pk_add_f32 v[46:47], v[46:47], v[138:139]
    s_waitcnt lgkmcnt(7)
    v_pk_add_f32 v[32:33], v[32:33], v[140:141]
    v_pk_add_f32 v[34:35], v[34:35], v[142:143]
    s_waitcnt lgkmcnt(6)
    v_pk_add_f32 v[36:37], v[36:37], v[144:145]
    v_pk_add_f32 v[38:39], v[38:39], v[146:147]
    s_waitcnt lgkmcnt(5)
    v_pk_add_f32 v[40:41], v[40:41], v[148:149]
    v_pk_add_f32 v[42:43], v[42:43], v[150:151]
    s_waitcnt lgkmcnt(4)
    v_pk_add_f32 v[44:45], v[44:45], v[152:153]
    v_pk_add_f32 v[46:47], v[46:47], v[154:155]
    s_waitcnt lgkmcnt(3)
    v_pk_add_f32 v[32:33], v[32:33], v[156:157]
    v_pk_add_f32 v[34:35], v[34:35], v[158:159]
    s_waitcnt lgkmcnt(2)
    v_pk_add_f32 v[36:37], v[36:37], v[160:161]
    v_pk_add_f32 v[38:39], v[38:39], v[162:163]
    s_waitcnt lgkmcnt(1)
    v_pk_add_f32 v[40:41], v[40:41], v[164:165]
    v_pk_add_f32 v[42:43], v[42:43], v[166:167]
    s_waitcnt lgkmcnt(0)
    v_pk_add_f32 v[44:45], v[44:45], v[168:169]
    v_pk_add_f32 v[46:47], v[46:47], v[170:171]
    v_cvt_pk_bf16_f32 v238, v32, v33
    v_cvt_pk_bf16_f32 v239, v34, v35
    v_cvt_pk_bf16_f32 v240, v36, v37
    v_cvt_pk_bf16_f32 v241, v38, v39
    v_cvt_pk_bf16_f32 v242, v40, v41
    v_cvt_pk_bf16_f32 v243, v42, v43
    v_cvt_pk_bf16_f32 v244, v44, v45
    v_cvt_pk_bf16_f32 v245, v46, v47
    buffer_store_dwordx4 v[238:241], v31, s[44:47], 0 offen
    buffer_store_dwordx4 v[242:245], v31, s[44:47], 0 offen offset:64
END:
    s_endpgm
.section .rodata,"a"
.p2align 6
.amdhsa_kernel sequential_preLN__sliding_local_dilated__dense_activation_relu__prompt_kernel
  .amdhsa_next_free_vgpr 512
  .amdhsa_next_free_sgpr 102
  .amdhsa_accum_offset 256
  .amdhsa_group_segment_fixed_size 0
  .amdhsa_kernarg_size 72
  .amdhsa_user_sgpr_count 2
  .amdhsa_user_sgpr_kernarg_segment_ptr 1
  .amdhsa_system_sgpr_workgroup_id_x 1
.end_amdhsa_kernel
```
